```python
import torch

def _softmax(x, axis=-1):
    return torch.softmax(x, dim=axis)
def _gelu(x):
    return torch.nn.functional.gelu(x, approximate="tanh")
def _silu(x):
    return torch.nn.functional.silu(x)
def _sigmoid(x):
    return torch.sigmoid(x)
def _layernorm(x, axis=-1, eps=1e-5):
    m = x.mean(dim=axis, keepdim=True)
    v = x.var(dim=axis, keepdim=True, unbiased=False)
    return (x - m) / torch.sqrt(v + eps)
def _scatter_add(tgt, idx, src, axis=0):
    return tgt.clone().index_add_(axis, idx, src)
def _segment_sum(src, seg, n):
    out = torch.zeros((n,) + src.shape[1:], dtype=src.dtype)
    return out.index_add_(0, seg, src)
def _pad(x, pw):
    flat = tuple(v for pair in reversed(pw) for v in pair)
    return torch.nn.functional.pad(x, flat)

kernel_name = 'concat_heads__ssm_conv_h3__grouped_kv_mqa__prompt'

def setup_inputs():

    _w = (lambda a: (lambda t: t.to(torch.bfloat16) if t.is_floating_point() else t)(torch.as_tensor(a)))
    def _A_setup():
        B, S, D = 1, 2048, 448
        ks = 4
        return {
            "q": _w((lambda *s: torch.randn(*s, dtype=torch.bfloat16) * 0.05)(B, S, D)),
            "k": _w((lambda *s: torch.randn(*s, dtype=torch.bfloat16) * 0.2)(B, S, D)),
            "v": _w((lambda *s: torch.randn(*s, dtype=torch.bfloat16) * 0.2)(B, S, D)),
            "shift_k": _w((lambda *s: torch.randn(*s, dtype=torch.bfloat16) * 0.2)(D, ks) * 0.5),
            "ssm_k": _w((lambda *s: torch.randn(*s, dtype=torch.bfloat16) * 0.4)(D, S) * (1.0 / S ** 0.5)),
            "ssm_D": _w((lambda *s: torch.randn(*s, dtype=torch.bfloat16) * 0.2)(D)),
        }
    _A_in = _A_setup()

    def _B_setup():
        B, S, D, H = 1, 2048, 448, 16
        Dh = D // H
        return {
            "x": _w((lambda *s: torch.randn(*s, dtype=torch.bfloat16) * 0.05)(B, S, D)),
            "wq": _w((lambda *s: torch.randn(*s, dtype=torch.bfloat16) * 0.8)(D, H * Dh)),
            "wk": _w((lambda *s: torch.randn(*s, dtype=torch.bfloat16) * 0.8)(D, Dh)),
            "wv": _w((lambda *s: torch.randn(*s, dtype=torch.bfloat16) * 0.05)(D, Dh)),
            "wo": _w((lambda *s: torch.randn(*s, dtype=torch.bfloat16) * 0.05)(H * Dh, D)),
        }
    _B_in = _B_setup()

    return {
        "A_q": _A_in["q"],
        "A_k": _A_in["k"],
        "A_v": _A_in["v"],
        "A_shift_k": _A_in["shift_k"],
        "A_ssm_k": _A_in["ssm_k"],
        "A_ssm_D": _A_in["ssm_D"],
        "B_x": _B_in["x"],
        "B_wq": _B_in["wq"],
        "B_wk": _B_in["wk"],
        "B_wv": _B_in["wv"],
        "B_wo": _B_in["wo"],
    }

def reference(A_q, A_k, A_v, A_shift_k, A_ssm_k, A_ssm_D, B_x, B_wq, B_wk, B_wv, B_wo):
    def _A_ref(q, k, v, shift_k, ssm_k, ssm_D):
        B, S, D = q.shape
        ks = shift_k.shape[-1]
        k_pad = _pad(k, ((0, 0), (ks - 1, 0), (0, 0)))
        k_shift = torch.zeros_like(k)
        for t in range(ks):
            k_shift = k_shift + k_pad[:, t:t + S, :] * shift_k[:, ks - 1 - t][None, None, :]
        kv = k_shift * v
        L = 2 * S
        kv_pad = _pad(kv, ((0, 0), (0, S), (0, 0)))
        kf_pad = _pad(ssm_k, ((0, 0), (0, S)))
        kv_f = (lambda x, axes=(-2,-1): torch.fft.rfft2(x.float(), dim=axes))(kv_pad[:, None, :, :], axes=(1, 2))
        kf_f = (lambda x, axes=(-2,-1): torch.fft.rfft2(x.float(), dim=axes))(kf_pad[:, None, :], axes=(1, 2))
        kf_f = (lambda x, *d: x.permute(*d))(kf_f, 1, 2, 0)
        y_f = kv_f * kf_f[None, :, :, :]
        y = (lambda x, s, axes=(-2,-1): torch.fft.irfft2(x, s=s, dim=axes).to(torch.bfloat16))(y_f, (1, L), axes=(1, 2))[:, 0, :S, :]
        y = y + kv * ssm_D[None, None, :]
        return q * y

    def _B_ref(x, wq, wk, wv, wo):
        B, S, D = x.shape
        H = 16
        Dh = D // H
        q = (lambda x, *d: x.permute(*d))((x @ wq).reshape(B, S, H, Dh), 0, 2, 1, 3)
        k = x @ wk
        v = x @ wv
        scores = torch.einsum("bhqd,bkd->bhqk", q, k) * (Dh ** -0.5)
        p = _softmax(scores, axis=-1)
        o = torch.einsum("bhqk,bkd->bhqd", p, v)
        return (lambda x, *d: x.permute(*d))(o, 0, 2, 1, 3).reshape(B, S, H * Dh) @ wo

    a = _A_ref(A_q, A_k, A_v, A_shift_k, A_ssm_k, A_ssm_D)
    b = _B_ref(B_x, B_wq, B_wk, B_wv, B_wo)
    return torch.concatenate([a, b], axis=-1)
```

```asm
; @launch grid=(256,1,1) block=(512,1,1) lds=158528
.amdgcn_target "amdgcn-amd-amdhsa--gfx950"
.text
.globl concat_heads__ssm_conv_h3__grouped_kv_mqa__prompt_kernel
.p2align 8
.type concat_heads__ssm_conv_h3__grouped_kv_mqa__prompt_kernel,@function
concat_heads__ssm_conv_h3__grouped_kv_mqa__prompt_kernel:
    s_cmp_ge_u32 s2, 256
    s_cbranch_scc1 L_end
    s_load_dwordx2 s[8:9], s[0:1], 8
    s_load_dwordx2 s[12:13], s[0:1], 16
    s_load_dwordx2 s[16:17], s[0:1], 24
    s_load_dwordx2 s[24:25], s[0:1], 48
    s_load_dwordx2 s[32:33], s[0:1], 64
    s_load_dwordx2 s[50:51], s[0:1], 72
    s_load_dwordx2 s[28:29], s[0:1], 56
    v_lshrrev_b32 v2, 6, v0
    v_and_b32 v1, 63, v0
    v_readfirstlane_b32 s60, v2
    s_and_b32 s66, s2, 7
    s_lshr_b32 s67, s2, 3
    s_and_b32 s68, s67, 3
    s_lshl_b32 s66, s66, 2
    s_add_u32 s61, s66, s68
    s_lshr_b32 s62, s67, 2
    s_mul_i32 s65, s61, 57344
    s_lshr_b32 s101, s60, 2
    s_and_b32 s95, s60, 3
    s_lshl_b32 s48, s62, 5
    s_add_u32 s48, s48, s61
    s_mov_b32 s26, 1835008
    s_mov_b32 s27, 0x20000
    s_mov_b32 s10, 1835008
    s_mov_b32 s11, 0x20000
    s_mov_b32 s14, 1835008
    s_mov_b32 s15, 0x20000
    s_mov_b32 s18, 3584
    s_mov_b32 s19, 0x20000
    s_mov_b32 s34, 25088
    s_mov_b32 s35, 0x20000
    s_mov_b32 s30, 401408
    s_mov_b32 s31, 0x20000
    s_mov_b32 s6, 1835008
    s_mov_b32 s7, 0x20000
    s_mov_b32 s22, 4096
    s_mov_b32 s23, 0x20000
    s_mov_b32 s38, 401408
    s_mov_b32 s39, 0x20000
    s_mov_b32 s42, 3670016
    s_mov_b32 s43, 0x20000
    s_mov_b32 s46, 16777216
    s_mov_b32 s47, 0x20000
    s_mov_b32 s54, 4096
    s_mov_b32 s55, 0x20000
    v_lshrrev_b32 v2, 3, v1
    v_and_b32 v3, 7, v1
    v_mov_b32 v6, 0
    v_mov_b32 v30, 1
    v_mov_b32 v31, 158464
    v_and_b32 v7, 15, v1
    v_lshl_add_u32 v7, v7, 2, v31
    ds_write_b32 v7, v6
    s_cmp_eq_u32 s62, 7
    s_cbranch_scc1 L_kvwg
    s_cmp_ge_u32 s60, 4
    s_cbranch_scc1 L_vpath
    s_waitcnt lgkmcnt(0)
    s_load_dwordx2 s[44:45], s[0:1], 104
    s_load_dwordx2 s[20:21], s[0:1], 32
    s_load_dwordx2 s[88:89], s[0:1], 40
    s_load_dwordx2 s[4:5], s[0:1], 0
    s_load_dwordx2 s[36:37], s[0:1], 80
    s_load_dwordx2 s[40:41], s[0:1], 88
    s_barrier
    s_waitcnt lgkmcnt(0)
    v_lshrrev_b32 v16, 3, v1
    v_lshrrev_b32 v17, 1, v16
    s_and_b32 s66, s60, 1
    s_lshl_b32 s66, s66, 2
    v_xor_b32 v17, v17, v1
    v_xor_b32 v17, s66, v17
    v_and_b32 v17, 7, v17
    s_lshl_b32 s66, s60, 3
    v_add_u32 v16, s66, v16
    v_mul_u32_u24 v16, 896, v16
    v_lshl_add_u32 v16, v17, 4, v16
    v_add_u32 v243, s65, v16
    s_lshl_b32 s57, s60, 10
    v_bfe_u32 v16, v1, 2, 2
    v_and_b32 v53, 1, v1
    v_and_b32 v50, 31, v1
    v_lshrrev_b32 v51, 5, v1
    v_bfe_u32 v52, v50, 1, 3
    v_xor_b32 v52, v52, v51
    s_lshr_b32 s66, s60, 1
    s_lshl_b32 s66, s66, 5
    v_add_u32 v17, s66, v50
    v_lshlrev_b32 v17, 7, v17
    v_lshl_add_u32 v57, v52, 4, v17
    v_xor_b32 v58, 32, v57
    v_xor_b32 v59, 64, v57
    v_xor_b32 v60, 96, v57
    v_bfe_u32 v52, v1, 1, 1
    v_lshl_add_u32 v53, v53, 1, v52
    v_bfe_u32 v52, v1, 4, 1
    v_lshl_add_u32 v53, v52, 2, v53
    v_min_u32 v53, 6, v53
    v_lshlrev_b32 v53, 3, v53
    v_mul_u32_u24 v51, 224, v51
    v_mul_u32_u24 v16, 12608, v16
    v_add3_u32 v53, v53, v51, v16
    s_and_b32 s66, s60, 1
    s_mul_i32 s66, s66, 56
    s_add_u32 s66, s66, 90624
    v_add_u32 v61, s66, v53
    v_lshlrev_b32 v16, 4, v1
    s_lshl_b32 s66, s60, 11
    s_add_u32 s66, s66, 141056
    v_add_u32 v62, s66, v16
    v_lshlrev_b32 v16, 4, v1
    s_lshl_b32 s66, s101, 14
    v_add_u32 v96, s66, v16
    v_lshlrev_b32 v111, 1, v96
    v_add_u32 v111, 57344, v111
    v_add_u32 v96, 57344, v96
    s_lshl_b32 s67, s95, 11
    s_add_u32 s100, s66, s67
    s_lshl_b32 s3, s100, 1
    s_add_u32 s3, s3, 57344
    s_add_u32 s100, s100, 57344
    s_lshl_b32 s66, s101, 16
    s_add_u32 s68, s66, 65536
    v_add_u32 v250, s68, v16
    s_add_u32 s66, s66, s67
    s_add_u32 s68, s66, 67584
    v_add_u32 v97, s68, v16
    s_add_u32 s68, s66, 196608
    v_add_u32 v99, s68, v16
    v_mov_b32 v98, 0xdddddddd
    s_lshl_b32 s66, s61, 16
    s_lshl_b32 s67, s62, 13
    s_add_u32 s66, s66, s67
    s_add_u32 s66, s66, 4194304
    s_lshl_b32 s67, s60, 10
    s_add_u32 s67, s66, s67
    v_add_u32 v251, s67, v16
    s_and_b32 s67, s60, 1
    s_lshl_b32 s67, s67, 12
    s_add_u32 s66, s66, s67
    s_bfe_u32 s67, s60, 0x10001
    s_lshl_b32 s67, s67, 11
    s_add_u32 s66, s66, s67
    s_lshl_b32 s67, s101, 9
    s_add_u32 s66, s66, s67
    v_bfe_u32 v21, v1, 4, 1
    v_lshlrev_b32 v20, 1, v21
    v_lshlrev_b32 v17, 10, v21
    v_lshrrev_b32 v18, 5, v1
    v_lshl_add_u32 v17, v18, 8, v17
    v_and_b32 v19, 15, v1
    v_lshl_add_u32 v17, v19, 4, v17
    v_add_u32 v108, s66, v17
    s_mul_i32 s66, s60, 3072
    s_add_u32 s66, s66, 32768
    v_add_u32 v248, s66, v16
    s_mov_b32 s58, s66
    s_mov_b32 s59, s67
    v_mov_b32 v46, v16
    v_mov_b32 v47, v17
    v_mov_b32 v45, v18
    s_mov_b32 s49, s68
    s_lshl_b32 s66, s60, 4
    v_add_u32 v16, s66, v1
    v_mul_u32_u24 v16, 896, v16
    s_lshl_b32 s66, s62, 7
    s_add_u32 s66, s66, s65
    s_mov_b64 exec, 0xffff
    buffer_load_dword v247, v16, s[24:27], s66 offen
    s_mov_b64 exec, -1
    s_min_u32 s66, s48, 223
    s_lshl_b32 s66, s66, 13
    s_add_u32 s52, s20, s66
    s_addc_u32 s53, s21, 0
    s_add_u32 s20, s52, 4096
    s_addc_u32 s21, s53, 0
    s_lshl_b32 s67, s95, 10
    v_lshlrev_b32 v16, 4, v1
    v_add_u32 v17, s67, v16
    v_add_u32 v228, 57344, v17
    v_add_u32 v229, 61440, v16
    v_subrev_u32 v18, 16, v17
    v_subrev_u32 v17, 32, v17
    v_add_u32 v16, 4064, v16
    buffer_load_dwordx4 v[192:195], v17, s[52:55], 0 offen
    buffer_load_dwordx2 v[196:197], v18, s[52:55], 0 offen
    buffer_load_dwordx4 v[204:207], v17, s[20:23], 0 offen
    buffer_load_dwordx2 v[208:209], v18, s[20:23], 0 offen
    s_mov_b64 exec, 3
    buffer_load_dwordx4 v[198:201], v16, s[52:55], 0 offen
    buffer_load_dwordx2 v[202:203], v16, s[52:55], 0 offen offset:16
    buffer_load_dwordx4 v[210:213], v16, s[20:23], 0 offen
    buffer_load_dwordx2 v[214:215], v16, s[20:23], 0 offen offset:16
    s_mov_b64 exec, -1
    s_min_u32 s66, s48, 223
    s_lshl_b32 s66, s66, 2
    s_load_dword s63, s[44:45], 0
    s_load_dword s64, s[88:89], s66
    s_getpc_b64 s[66:67]
L_pc1:
    s_sub_u32 s66, s66, L_pc1-concat_heads__ssm_conv_h3__grouped_kv_mqa__prompt_kernel
    s_subb_u32 s67, s67, 0
    s_lshr_b32 s68, s2, 3
    s_lshl_b32 s68, s68, 2
    s_add_u32 s68, s68, s95
    s_lshl_b32 s68, s68, 9
    v_lshlrev_b32 v44, 7, v1
    v_add_u32 v44, s68, v44
    v_min_u32 v44, L_end-concat_heads__ssm_conv_h3__grouped_kv_mqa__prompt_kernel, v44
    s_mov_b64 exec, 15
    global_load_dword v247, v44, s[66:67]
    s_mov_b64 exec, -1
    s_mov_b32 s66, s58
    s_mov_b32 s67, s59
    v_mov_b32 v16, v46
    v_mov_b32 v17, v47
    v_mov_b32 v18, v45
    s_mov_b32 s68, s49
    s_xor_b32 s67, s60, 4
    s_mul_i32 s67, s67, 3072
    s_add_u32 s67, s67, 32768
    v_add_u32 v249, s67, v16
    v_lshlrev_b32 v17, 5, v19
    v_lshl_add_u32 v17, v18, 4, v17
    v_lshlrev_b32 v21, 3, v21
    s_mul_i32 s66, s101, 8192
    s_add_u32 s66, s66, 141056
    s_lshl_b32 s67, s95, 11
    s_add_u32 s68, s66, s67
    v_add_u32 v104, s68, v16
    s_xor_b32 s67, s67, 4096
    s_add_u32 s66, s66, s67
    v_add_u32 v105, s66, v16
    v_add3_u32 v106, v17, v21, s66
    v_sub_u32 v17, v17, v21
    s_and_b32 s67, s60, 1
    s_bfe_u32 s68, s60, 0x10001
    s_lshl_b32 s68, s68, 2
    s_add_u32 s68, s68, s67
    s_lshl_b32 s68, s68, 9
    s_mul_i32 s66, s101, 4608
    s_add_u32 s66, s66, s68
    s_add_u32 s66, s66, 149768
    v_add_u32 v240, s66, v17
    s_lshl_b32 s67, s67, 10
    s_sub_u32 s67, 1536, s67
    v_mul_lo_u32 v17, v18, s67
    v_and_b32 v22, 31, v1
    v_lshlrev_b32 v22, 4, v22
    s_lshl_b32 s66, s48, 13
    s_lshl_b32 s67, s101, 12
    s_add_u32 s66, s66, s67
    s_add_u32 s66, s66, s68
    s_add_u32 s66, s66, 2228224
    v_add3_u32 v107, v17, v22, s66
    s_min_u32 s69, s48, 223
    s_and_b32 s66, s2, 7
    s_lshl_b32 s66, s66, 12
    s_add_u32 s66, s66, 9502720
    v_add_u32 v242, s66, v22
    s_lshl_b32 s66, s69, 13
    s_lshl_b32 s67, s60, 10
    s_add_u32 s66, s66, s67
    s_add_u32 s66, s66, 393216
    v_add_u32 v255, s66, v16
    s_lshl_b32 s66, s101, 9
    s_add_u32 s66, s66, s67
    s_add_u32 s66, s66, 149760
    v_add_u32 v254, s66, v16
    v_lshrrev_b32 v21, 3, v1
    v_lshlrev_b32 v17, 2, v21
    v_add_u32 v17, s95, v17
    v_mul_u32_u24 v17, 896, v17
    v_xor_b32 v20, v20, v1
    v_and_b32 v20, 7, v20
    v_lshl_add_u32 v17, v20, 4, v17
    s_min_u32 s68, s62, 6
    s_lshl_b32 s69, s68, 7
    v_add_u32 v252, s69, v17
    s_mul_i32 s50, s101, 200704
    s_mul_i32 s94, s95, 14400
    s_mul_i32 s66, s101, 7168
    s_add_u32 s94, s94, s66
    s_add_u32 s94, s94, 90624
    v_and_b32 v20, 7, v1
    s_lshl_b32 s66, s68, 5
    v_add_u32 v17, s66, v1
    v_lshlrev_b32 v22, 5, v20
    v_cmp_gt_u32 vcc, 32, v1
    v_add_u32 v22, s61, v22
    s_nop 0
    v_cndmask_b32 v17, v22, v17, vcc
    v_lshlrev_b32 v17, 7, v17
    v_add_u32 v4, 9568256, v17
    s_lshl_b32 s66, s60, 3
    v_add_u32 v17, s66, v21
    v_lshlrev_b32 v22, 4, v20
    v_lshl_add_u32 v23, v17, 12, v22
    s_lshl_b32 s66, s61, 7
    s_lshl_b32 s67, s68, 18
    s_add_u32 s66, s66, s67
    s_add_u32 s66, s66, 2228224
    v_add_u32 v5, s66, v23
    v_mul_u32_u24 v17, 896, v17
    v_add_u32 v17, s65, v17
    v_add_u32 v22, s69, v22
    v_add_u32 v6, v17, v22
    v_lshl_add_u32 v110, v17, 1, v22
    v_xor_b32 v22, s60, v20
    v_lshlrev_b32 v22, 4, v22
    v_lshl_add_u32 v23, v21, 7, v22
    s_lshl_b32 s68, s60, 10
    s_add_u32 s68, s68, 149248
    v_add_u32 v7, s68, v23
    v_lshl_add_u32 v22, v20, 10, v22
    v_lshl_add_u32 v22, v21, 1, v22
    v_add_u32 v109, 149248, v22
    v_lshrrev_b32 v18, 4, v1
    v_mul_u32_u24 v22, 14400, v18
    v_lshl_add_u32 v22, v19, 2, v22
    v_add_u32 v253, 104960, v22
    v_mov_b32 v100, -1
    v_mov_b32 v101, -1
    v_mov_b32 v102, -1
    v_mov_b32 v103, -1
    v_mov_b32 v80, 0
    v_mov_b32 v81, 0
    v_mov_b32 v82, 0
    v_mov_b32 v83, 0
    v_mov_b32 v84, 0
    v_mov_b32 v85, 0
    v_mov_b32 v86, 0
    v_mov_b32 v87, 0
    v_mov_b32 v88, 0
    v_mov_b32 v89, 0
    v_mov_b32 v90, 0
    v_mov_b32 v91, 0
    v_mov_b32 v92, 0
    v_mov_b32 v93, 0
    v_mov_b32 v94, 0
    v_mov_b32 v95, 0
    v_mov_b32 v64, 0
    v_mov_b32 v65, 0
    v_mov_b32 v66, 0
    v_mov_b32 v67, 0
    v_mov_b32 v68, 0
    v_mov_b32 v69, 0
    v_mov_b32 v70, 0
    v_mov_b32 v71, 0
    v_mov_b32 v72, 0
    v_mov_b32 v73, 0
    v_mov_b32 v74, 0
    v_mov_b32 v75, 0
    v_mov_b32 v76, 0
    v_mov_b32 v77, 0
    v_mov_b32 v78, 0
    v_mov_b32 v79, 0
    v_add_u32 v17, 1, v19
    v_and_b32 v17, 3, v17
    v_add_u32 v20, 25, v19
    v_sub_u32 v20, v20, v17
    v_lshlrev_b32 v21, 3, v18
    v_sub_u32 v20, v20, v21
    v_lshlrev_b32 v20, 1, v20
    v_mul_u32_u24 v17, 4160, v17
    s_bfe_u32 s67, s60, 0x10001
    s_lshl_b32 s67, s67, 8
    s_mul_i32 s66, s101, 16640
    s_add_u32 s66, s66, s67
    s_add_u32 s66, s66, 57344
    v_add3_u32 v2, v20, v17, s66
    v_lshlrev_b32 v17, 5, v19
    v_lshl_add_u32 v17, v18, 4, v17
    s_mul_i32 s66, s101, 4608
    s_sub_u32 s66, s66, s67
    s_add_u32 s66, s66, 149536
    v_add_u32 v3, s66, v17
    v_mul_u32_u24 v16, 37, v1
    v_lshrrev_b32 v16, 8, v16
    v_mul_u32_u24 v17, 7, v16
    v_sub_u32 v17, v1, v17
    v_lshlrev_b32 v16, 2, v16
    v_add_u32 v16, s95, v16
    v_mul_u32_u24 v16, 896, v16
    v_lshl_add_u32 v16, v17, 4, v16
    s_mul_i32 s69, s62, 112
    s_mul_i32 s66, s101, 200704
    s_add_u32 s69, s69, s66
    v_add_u32 v241, s69, v16
    s_mul_i32 s56, s95, 12608
    s_mul_i32 s66, s101, 6272
    s_add_u32 s56, s56, s66
    s_add_u32 s56, s56, 90624
    s_and_b32 s98, s61, 3
    s_mul_i32 s98, s98, 1792
    s_lshl_b32 s66, s95, 3
    v_lshrrev_b32 v16, 3, v1
    v_add_u32 v16, s66, v16
    v_mul_u32_u24 v16, 1792, v16
    s_lshl_b32 s66, s48, 1
    s_add_u32 s66, s66, s101
    s_lshl_b32 s66, s66, 2
    s_add_u32 s66, s66, 6291456
    v_add_u32 v39, s66, v16
    v_and_b32 v48, 7, v1
    v_lshlrev_b32 v48, 2, v48
    v_add_u32 v49, 1, v48
    v_add_u32 v50, 2, v48
    v_add_u32 v51, 3, v48
    s_waitcnt lgkmcnt(0)
    s_mul_i32 s63, s63, 0x9E3779B1
    s_add_u32 s63, s63, 0x7F4A7C15
    s_lshl_b32 s66, s64, 16
    s_and_b32 s64, s64, 0xffff0000
    s_cmp_eq_u32 s101, 0
    s_cselect_b32 s64, s66, s64
L_ms5:
    ds_read_b32 v52, v31 offset:48
    s_waitcnt lgkmcnt(0)
    v_cmp_gt_u32 vcc, 4, v52
    s_cbranch_vccnz L_ms5
    s_add_u32 m0, s57, 0
    s_nop 0
    buffer_load_dwordx4 v243, s[24:27], 0 offen offset:0 lds
    s_add_u32 m0, s57, 8064
    s_nop 0
    buffer_load_dwordx4 v243, s[24:27], 0 offen offset:128 lds
    s_add_u32 m0, s57, 16128
    s_nop 0
    buffer_load_dwordx4 v243, s[24:27], 0 offen offset:256 lds
    s_add_u32 m0, s57, 24192
    s_nop 0
    buffer_load_dwordx4 v243, s[24:27], 0 offen offset:384 lds
    s_waitcnt vmcnt(4)
    v_alignbit_b32 v160, v193, v192, 16
    v_alignbit_b32 v161, v194, v193, 16
    v_alignbit_b32 v162, v195, v194, 16
    v_alignbit_b32 v163, v196, v195, 16
    ds_write_b128 v228, v[192:195] offset:0
    ds_write_b128 v228, v[160:163] offset:4160
    v_mov_b32 v164, v193
    v_mov_b32 v165, v194
    v_mov_b32 v166, v195
    v_mov_b32 v167, v196
    ds_write_b128 v228, v[164:167] offset:8320
    v_alignbit_b32 v168, v194, v193, 16
    v_alignbit_b32 v169, v195, v194, 16
    v_alignbit_b32 v170, v196, v195, 16
    v_alignbit_b32 v171, v197, v196, 16
    ds_write_b128 v228, v[168:171] offset:12480
    v_alignbit_b32 v172, v205, v204, 16
    v_alignbit_b32 v173, v206, v205, 16
    v_alignbit_b32 v174, v207, v206, 16
    v_alignbit_b32 v175, v208, v207, 16
    ds_write_b128 v228, v[204:207] offset:16640
    ds_write_b128 v228, v[172:175] offset:20800
    v_mov_b32 v176, v205
    v_mov_b32 v177, v206
    v_mov_b32 v178, v207
    v_mov_b32 v179, v208
    ds_write_b128 v228, v[176:179] offset:24960
    v_alignbit_b32 v180, v206, v205, 16
    v_alignbit_b32 v181, v207, v206, 16
    v_alignbit_b32 v182, v208, v207, 16
    v_alignbit_b32 v183, v209, v208, 16
    ds_write_b128 v228, v[180:183] offset:29120
    s_mov_b64 exec, 3
    v_alignbit_b32 v216, v199, v198, 16
    v_alignbit_b32 v217, v200, v199, 16
    v_alignbit_b32 v218, v201, v200, 16
    v_alignbit_b32 v219, v202, v201, 16
    ds_write_b128 v229, v[198:201] offset:0
    ds_write_b128 v229, v[216:219] offset:4160
    v_mov_b32 v220, v199
    v_mov_b32 v221, v200
    v_mov_b32 v222, v201
    v_mov_b32 v223, v202
    ds_write_b128 v229, v[220:223] offset:8320
    v_alignbit_b32 v224, v200, v199, 16
    v_alignbit_b32 v225, v201, v200, 16
    v_alignbit_b32 v226, v202, v201, 16
    v_alignbit_b32 v227, v203, v202, 16
    ds_write_b128 v229, v[224:227] offset:12480
    v_alignbit_b32 v160, v211, v210, 16
    v_alignbit_b32 v161, v212, v211, 16
    v_alignbit_b32 v162, v213, v212, 16
    v_alignbit_b32 v163, v214, v213, 16
    ds_write_b128 v229, v[210:213] offset:16640
    ds_write_b128 v229, v[160:163] offset:20800
    v_mov_b32 v164, v211
    v_mov_b32 v165, v212
    v_mov_b32 v166, v213
    v_mov_b32 v167, v214
    ds_write_b128 v229, v[164:167] offset:24960
    v_alignbit_b32 v168, v212, v211, 16
    v_alignbit_b32 v169, v213, v212, 16
    v_alignbit_b32 v170, v214, v213, 16
    v_alignbit_b32 v171, v215, v214, 16
    ds_write_b128 v229, v[168:171] offset:29120
    s_mov_b64 exec, -1
    s_waitcnt vmcnt(0)
    s_mov_b32 s71, 0
L_xtm:
    buffer_load_dwordx4 v[40:43], v255, s[44:47], 0 offen sc1
    buffer_load_dword v38, v39, s[44:47], 0 offen sc1
    s_mov_b64 exec, -1
    s_waitcnt vmcnt(0)
L_xtm_chk:
    v_alignbit_b32 v44, v40, v40, v48
    v_alignbit_b32 v45, v41, v41, v49
    v_alignbit_b32 v46, v42, v42, v50
    v_alignbit_b32 v47, v43, v43, v51
    v_add3_u32 v44, v44, v45, v46
    v_add_u32 v44, v44, v47
    s_nop 1
    v_add_u32_dpp v44, v44, v44 quad_perm:[1,0,3,2] row_mask:0xf bank_mask:0xf
    s_nop 1
    v_add_u32_dpp v44, v44, v44 quad_perm:[2,3,0,1] row_mask:0xf bank_mask:0xf
    s_nop 1
    v_add_u32_dpp v44, v44, v44 row_half_mirror row_mask:0xf bank_mask:0xf
    v_add_u32 v44, s63, v44
    v_cmp_ne_u32 vcc, v44, v38
    s_add_u32 s71, s71, 1
    s_cbranch_vccz L_xtm_ok
    s_cmp_gt_u32 s71, 262144
    s_cbranch_scc1 L_xtm_ok
    s_mov_b64 exec, vcc
    s_sleep 2
    s_branch L_xtm
L_xtm_ok:
    ds_write_b128 v254, v[40:43]
    s_waitcnt lgkmcnt(0)
    s_barrier
    s_branch L_conv
L_kvwg:
    v_lshrrev_b32 v16, 3, v1
    v_lshrrev_b32 v17, 1, v16
    s_and_b32 s66, s60, 1
    s_lshl_b32 s66, s66, 2
    v_xor_b32 v17, v17, v1
    v_xor_b32 v17, s66, v17
    v_and_b32 v17, 7, v17
    s_lshl_b32 s66, s60, 3
    v_add_u32 v16, s66, v16
    v_mul_u32_u24 v16, 896, v16
    v_lshl_add_u32 v16, v17, 4, v16
    v_add_u32 v243, s65, v16
    s_lshl_b32 s57, s60, 10
    s_lshl_b32 s68, s95, 10
    v_lshlrev_b32 v18, 4, v1
    v_add_u32 v18, s68, v18
    s_mul_i32 s70, s101, 28672
    s_add_u32 s70, s70, s68
    s_waitcnt lgkmcnt(0)
    s_barrier
    s_cmp_ge_u32 s60, 4
    s_cselect_b32 s32, s50, s32
    s_cselect_b32 s33, s51, s33
    s_and_b32 s71, s61, 3
    s_lshl_b32 s71, s71, 13
    s_add_u32 s70, s70, 90624
    s_add_u32 m0, s70, s71
    s_add_u32 s66, s71, 4096
    buffer_load_dwordx4 v18, s[32:35], s71 offen lds
    s_cmp_eq_u32 s66, 28672
    s_cselect_b32 s71, 0, s66
    s_load_dwordx2 s[44:45], s[0:1], 104
    s_load_dwordx2 s[20:21], s[0:1], 32
    s_load_dwordx2 s[88:89], s[0:1], 40
    s_load_dwordx2 s[4:5], s[0:1], 0
    s_load_dwordx2 s[36:37], s[0:1], 80
    s_load_dwordx2 s[40:41], s[0:1], 88
    s_add_u32 m0, s70, s71
    s_add_u32 s66, s71, 4096
    buffer_load_dwordx4 v18, s[32:35], s71 offen lds
    s_cmp_eq_u32 s66, 28672
    s_cselect_b32 s71, 0, s66
    s_add_u32 m0, s70, s71
    s_add_u32 s66, s71, 4096
    buffer_load_dwordx4 v18, s[32:35], s71 offen lds
    s_cmp_eq_u32 s66, 28672
    s_cselect_b32 s71, 0, s66
    s_add_u32 m0, s70, s71
    s_add_u32 s66, s71, 4096
    buffer_load_dwordx4 v18, s[32:35], s71 offen lds
    s_cmp_eq_u32 s66, 28672
    s_cselect_b32 s71, 0, s66
    s_add_u32 m0, s70, s71
    s_add_u32 s66, s71, 4096
    buffer_load_dwordx4 v18, s[32:35], s71 offen lds
    s_cmp_eq_u32 s66, 28672
    s_cselect_b32 s71, 0, s66
    s_add_u32 m0, s70, s71
    s_add_u32 s66, s71, 4096
    buffer_load_dwordx4 v18, s[32:35], s71 offen lds
    s_cmp_eq_u32 s66, 28672
    s_cselect_b32 s71, 0, s66
    s_add_u32 m0, s70, s71
    s_add_u32 s66, s71, 4096
    buffer_load_dwordx4 v18, s[32:35], s71 offen lds
    s_cmp_eq_u32 s66, 28672
    s_cselect_b32 s71, 0, s66
    s_add_u32 m0, s57, 0
    s_nop 0
    buffer_load_dwordx4 v243, s[24:27], 0 offen offset:0 lds
    s_add_u32 m0, s57, 8064
    s_nop 0
    buffer_load_dwordx4 v243, s[24:27], 0 offen offset:128 lds
    s_add_u32 m0, s57, 16128
    s_nop 0
    buffer_load_dwordx4 v243, s[24:27], 0 offen offset:256 lds
    s_add_u32 m0, s57, 24192
    s_nop 0
    buffer_load_dwordx4 v243, s[24:27], 0 offen offset:384 lds
    s_add_u32 m0, s57, 32256
    s_nop 0
    buffer_load_dwordx4 v243, s[24:27], 0 offen offset:512 lds
    s_add_u32 m0, s57, 40320
    s_nop 0
    buffer_load_dwordx4 v243, s[24:27], 0 offen offset:640 lds
    s_add_u32 m0, s57, 48384
    s_nop 0
    buffer_load_dwordx4 v243, s[24:27], 0 offen offset:768 lds
    s_waitcnt lgkmcnt(0)
    s_min_u32 s66, s48, 223
    s_lshl_b32 s66, s66, 2
    s_load_dword s63, s[44:45], 0
    s_load_dword s64, s[88:89], s66
    s_cmp_ge_u32 s60, 4
    s_cbranch_scc0 L_kvpf_ne
L_kvpf_ne:
    v_bfe_u32 v16, v1, 2, 2
    v_and_b32 v53, 1, v1
    v_and_b32 v50, 31, v1
    v_lshrrev_b32 v51, 5, v1
    v_bfe_u32 v52, v50, 1, 3
    v_xor_b32 v52, v52, v51
    s_lshr_b32 s66, s60, 1
    s_lshl_b32 s66, s66, 5
    v_add_u32 v17, s66, v50
    v_lshlrev_b32 v17, 7, v17
    v_lshl_add_u32 v57, v52, 4, v17
    v_xor_b32 v58, 32, v57
    v_xor_b32 v59, 64, v57
    v_xor_b32 v60, 96, v57
    v_bfe_u32 v52, v1, 1, 1
    v_lshl_add_u32 v53, v53, 1, v52
    v_bfe_u32 v52, v1, 4, 1
    v_lshl_add_u32 v53, v52, 2, v53
    v_min_u32 v53, 6, v53
    v_lshlrev_b32 v53, 3, v53
    v_mul_u32_u24 v51, 224, v51
    v_mul_u32_u24 v16, 12608, v16
    v_add3_u32 v53, v53, v51, v16
    s_and_b32 s66, s60, 1
    s_mul_i32 s66, s66, 56
    s_add_u32 s66, s66, 90624
    v_add_u32 v61, s66, v53
    v_lshlrev_b32 v16, 4, v1
    s_lshl_b32 s66, s60, 11
    s_add_u32 s66, s66, 141056
    v_add_u32 v62, s66, v16
    v_lshlrev_b32 v16, 4, v1
    s_lshl_b32 s66, s101, 14
    v_add_u32 v96, s66, v16
    v_lshlrev_b32 v111, 1, v96
    v_add_u32 v111, 57344, v111
    v_add_u32 v96, 57344, v96
    s_lshl_b32 s67, s95, 11
    s_add_u32 s100, s66, s67
    s_lshl_b32 s3, s100, 1
    s_add_u32 s3, s3, 57344
    s_add_u32 s100, s100, 57344
    s_lshl_b32 s66, s101, 16
    s_add_u32 s68, s66, 65536
    v_add_u32 v250, s68, v16
    s_add_u32 s66, s66, s67
    s_add_u32 s68, s66, 67584
    v_add_u32 v97, s68, v16
    s_add_u32 s68, s66, 196608
    v_add_u32 v99, s68, v16
    v_mov_b32 v98, 0xdddddddd
    s_lshl_b32 s66, s61, 16
    s_lshl_b32 s67, s62, 13
    s_add_u32 s66, s66, s67
    s_add_u32 s66, s66, 4194304
    s_lshl_b32 s67, s60, 10
    s_add_u32 s67, s66, s67
    v_add_u32 v251, s67, v16
    s_and_b32 s67, s60, 1
    s_lshl_b32 s67, s67, 12
    s_add_u32 s66, s66, s67
    s_bfe_u32 s67, s60, 0x10001
    s_lshl_b32 s67, s67, 11
    s_add_u32 s66, s66, s67
    s_lshl_b32 s67, s101, 9
    s_add_u32 s66, s66, s67
    v_bfe_u32 v21, v1, 4, 1
    v_lshlrev_b32 v20, 1, v21
    v_lshlrev_b32 v17, 10, v21
    v_lshrrev_b32 v18, 5, v1
    v_lshl_add_u32 v17, v18, 8, v17
    v_and_b32 v19, 15, v1
    v_lshl_add_u32 v17, v19, 4, v17
    v_add_u32 v108, s66, v17
    s_mul_i32 s66, s60, 3072
    s_add_u32 s66, s66, 32768
    v_add_u32 v248, s66, v16
    s_xor_b32 s67, s60, 4
    s_mul_i32 s67, s67, 3072
    s_add_u32 s67, s67, 32768
    v_add_u32 v249, s67, v16
    v_lshlrev_b32 v17, 5, v19
    v_lshl_add_u32 v17, v18, 4, v17
    v_lshlrev_b32 v21, 3, v21
    s_mul_i32 s66, s101, 8192
    s_add_u32 s66, s66, 141056
    s_lshl_b32 s67, s95, 11
    s_add_u32 s68, s66, s67
    v_add_u32 v104, s68, v16
    s_xor_b32 s67, s67, 4096
    s_add_u32 s66, s66, s67
    v_add_u32 v105, s66, v16
    v_add3_u32 v106, v17, v21, s66
    v_sub_u32 v17, v17, v21
    s_and_b32 s67, s60, 1
    s_bfe_u32 s68, s60, 0x10001
    s_lshl_b32 s68, s68, 2
    s_add_u32 s68, s68, s67
    s_lshl_b32 s68, s68, 9
    s_mul_i32 s66, s101, 4608
    s_add_u32 s66, s66, s68
    s_add_u32 s66, s66, 149768
    v_add_u32 v240, s66, v17
    s_lshl_b32 s67, s67, 10
    s_sub_u32 s67, 1536, s67
    v_mul_lo_u32 v17, v18, s67
    v_and_b32 v22, 31, v1
    v_lshlrev_b32 v22, 4, v22
    s_lshl_b32 s66, s48, 13
    s_lshl_b32 s67, s101, 12
    s_add_u32 s66, s66, s67
    s_add_u32 s66, s66, s68
    s_add_u32 s66, s66, 2228224
    v_add3_u32 v107, v17, v22, s66
    s_min_u32 s69, s48, 223
    s_and_b32 s66, s2, 7
    s_lshl_b32 s66, s66, 12
    s_add_u32 s66, s66, 9502720
    v_add_u32 v242, s66, v22
    s_lshl_b32 s66, s69, 13
    s_lshl_b32 s67, s60, 10
    s_add_u32 s66, s66, s67
    s_add_u32 s66, s66, 393216
    v_add_u32 v255, s66, v16
    s_lshl_b32 s66, s101, 9
    s_add_u32 s66, s66, s67
    s_add_u32 s66, s66, 149760
    v_add_u32 v254, s66, v16
    v_lshrrev_b32 v21, 3, v1
    v_lshlrev_b32 v17, 2, v21
    v_add_u32 v17, s95, v17
    v_mul_u32_u24 v17, 896, v17
    v_xor_b32 v20, v20, v1
    v_and_b32 v20, 7, v20
    v_lshl_add_u32 v17, v20, 4, v17
    s_min_u32 s68, s62, 6
    s_lshl_b32 s69, s68, 7
    v_add_u32 v252, s69, v17
    s_mul_i32 s50, s101, 200704
    s_mul_i32 s94, s95, 14400
    s_mul_i32 s66, s101, 7168
    s_add_u32 s94, s94, s66
    s_add_u32 s94, s94, 90624
    v_and_b32 v20, 7, v1
    s_lshl_b32 s66, s68, 5
    v_add_u32 v17, s66, v1
    v_lshlrev_b32 v22, 5, v20
    v_cmp_gt_u32 vcc, 32, v1
    v_add_u32 v22, s61, v22
    s_nop 0
    v_cndmask_b32 v17, v22, v17, vcc
    v_lshlrev_b32 v17, 7, v17
    v_add_u32 v4, 9568256, v17
    s_lshl_b32 s66, s60, 3
    v_add_u32 v17, s66, v21
    v_lshlrev_b32 v22, 4, v20
    v_lshl_add_u32 v23, v17, 12, v22
    s_lshl_b32 s66, s61, 7
    s_lshl_b32 s67, s68, 18
    s_add_u32 s66, s66, s67
    s_add_u32 s66, s66, 2228224
    v_add_u32 v5, s66, v23
    v_mul_u32_u24 v17, 896, v17
    v_add_u32 v17, s65, v17
    v_add_u32 v22, s69, v22
    v_add_u32 v6, v17, v22
    v_lshl_add_u32 v110, v17, 1, v22
    v_xor_b32 v22, s60, v20
    v_lshlrev_b32 v22, 4, v22
    v_lshl_add_u32 v23, v21, 7, v22
    s_lshl_b32 s68, s60, 10
    s_add_u32 s68, s68, 149248
    v_add_u32 v7, s68, v23
    v_lshl_add_u32 v22, v20, 10, v22
    v_lshl_add_u32 v22, v21, 1, v22
    v_add_u32 v109, 149248, v22
    v_lshrrev_b32 v18, 4, v1
    v_mul_u32_u24 v22, 14400, v18
    v_lshl_add_u32 v22, v19, 2, v22
    v_add_u32 v253, 104960, v22
    v_mov_b32 v100, -1
    v_mov_b32 v101, -1
    v_mov_b32 v102, -1
    v_mov_b32 v103, -1
    v_mov_b32 v80, 0
    v_mov_b32 v81, 0
    v_mov_b32 v82, 0
    v_mov_b32 v83, 0
    v_mov_b32 v84, 0
    v_mov_b32 v85, 0
    v_mov_b32 v86, 0
    v_mov_b32 v87, 0
    v_mov_b32 v88, 0
    v_mov_b32 v89, 0
    v_mov_b32 v90, 0
    v_mov_b32 v91, 0
    v_mov_b32 v92, 0
    v_mov_b32 v93, 0
    v_mov_b32 v94, 0
    v_mov_b32 v95, 0
    v_mov_b32 v64, 0
    v_mov_b32 v65, 0
    v_mov_b32 v66, 0
    v_mov_b32 v67, 0
    v_mov_b32 v68, 0
    v_mov_b32 v69, 0
    v_mov_b32 v70, 0
    v_mov_b32 v71, 0
    v_mov_b32 v72, 0
    v_mov_b32 v73, 0
    v_mov_b32 v74, 0
    v_mov_b32 v75, 0
    v_mov_b32 v76, 0
    v_mov_b32 v77, 0
    v_mov_b32 v78, 0
    v_mov_b32 v79, 0
    v_add_u32 v17, 1, v19
    v_and_b32 v17, 3, v17
    v_add_u32 v20, 25, v19
    v_sub_u32 v20, v20, v17
    v_lshlrev_b32 v21, 3, v18
    v_sub_u32 v20, v20, v21
    v_lshlrev_b32 v20, 1, v20
    v_mul_u32_u24 v17, 4160, v17
    s_bfe_u32 s67, s60, 0x10001
    s_lshl_b32 s67, s67, 8
    s_mul_i32 s66, s101, 16640
    s_add_u32 s66, s66, s67
    s_add_u32 s66, s66, 57344
    v_add3_u32 v2, v20, v17, s66
    v_lshlrev_b32 v17, 5, v19
    v_lshl_add_u32 v17, v18, 4, v17
    s_mul_i32 s66, s101, 4608
    s_sub_u32 s66, s66, s67
    s_add_u32 s66, s66, 149536
    v_add_u32 v3, s66, v17
    v_mul_u32_u24 v16, 37, v1
    v_lshrrev_b32 v16, 8, v16
    v_mul_u32_u24 v17, 7, v16
    v_sub_u32 v17, v1, v17
    v_lshlrev_b32 v16, 2, v16
    v_add_u32 v16, s95, v16
    v_mul_u32_u24 v16, 896, v16
    v_lshl_add_u32 v16, v17, 4, v16
    s_mul_i32 s69, s62, 112
    s_mul_i32 s66, s101, 200704
    s_add_u32 s69, s69, s66
    v_add_u32 v241, s69, v16
    s_mul_i32 s56, s95, 12608
    s_mul_i32 s66, s101, 6272
    s_add_u32 s56, s56, s66
    s_add_u32 s56, s56, 90624
    s_and_b32 s98, s61, 3
    s_mul_i32 s98, s98, 1792
    v_bfe_u32 v16, v1, 2, 2
    v_lshrrev_b32 v17, 5, v1
    v_lshl_add_u32 v16, v17, 3, v16
    v_mul_u32_u24 v16, 56, v16
    v_bfe_u32 v17, v1, 4, 1
    v_lshl_add_u32 v16, v17, 5, v16
    v_and_b32 v17, 3, v1
    v_lshl_add_u32 v16, v17, 3, v16
    s_and_b32 s67, s60, 1
    s_mul_i32 s66, s67, 28672
    s_add_u32 s66, s66, 90624
    v_add_u32 v24, s66, v16
    s_mul_i32 s66, s67, 131072
    s_lshl_b32 s68, s61, 12
    s_add_u32 s66, s66, s68
    s_bfe_u32 s68, s60, 0x10001
    s_lshl_b32 s68, s68, 11
    s_add_u32 s66, s66, s68
    s_add_u32 s66, s66, 65536
    v_lshlrev_b32 v16, 4, v1
    v_add_u32 v25, s66, v16
    s_lshl_b32 s66, s67, 2
    s_add_u32 s66, s66, 158468
    v_mov_b32 v29, s66
    v_and_b32 v16, 31, v1
    s_cmp_eq_u32 s67, 0
    s_cselect_b32 s68, 32, 28
    s_cselect_b32 s69, 32, 64
    s_cselect_b32 s66, 63, 28
    v_cmp_gt_u32 vcc, s68, v16
    v_mov_b32 v17, 0x3f803f80
    s_nop 0
    v_cndmask_b32 v26, 0, -1, vcc
    v_cmp_gt_u32 vcc, s69, v1
    s_nop 1
    v_cndmask_b32 v27, 0, v26, vcc
    v_cmp_eq_u32 vcc, s66, v16
    s_lshl_b32 s66, s61, 4
    s_add_u32 s66, s66, 9502720
    v_cndmask_b32 v28, 0, v17, vcc
    v_lshlrev_b32 v63, 12, v1
    v_add_u32 v63, s66, v63
    s_waitcnt lgkmcnt(0)
    s_mul_i32 s63, s63, 0x9E3779B1
    s_add_u32 s63, s63, 0x7F4A7C15
    s_lshl_b32 s66, s64, 16
    s_and_b32 s64, s64, 0xffff0000
    s_cmp_eq_u32 s101, 0
    s_cselect_b32 s64, s66, s64
    s_waitcnt vmcnt(0)
    s_barrier
    s_cmp_ge_u32 s60, 4
    s_cbranch_scc1 L_kv_v
    s_bitcmp1_b32 s60, 0
    s_cbranch_scc1 L_vgemm
    ds_read_b64_tr_b16 v[112:113], v24 offset:0
    ds_read_b64_tr_b16 v[114:115], v24 offset:224
    ds_read_b128 v[116:119], v57 offset:0
    ds_read_b64_tr_b16 v[120:121], v24 offset:896
    ds_read_b64_tr_b16 v[122:123], v24 offset:1120
    ds_read_b128 v[124:127], v58 offset:0
    ds_read_b64_tr_b16 v[128:129], v24 offset:1792
    ds_read_b64_tr_b16 v[130:131], v24 offset:2016
    ds_read_b128 v[132:135], v59 offset:0
    ds_read_b64_tr_b16 v[136:137], v24 offset:2688
    ds_read_b64_tr_b16 v[138:139], v24 offset:2912
    ds_read_b128 v[140:143], v60 offset:0
    ds_read_b64_tr_b16 v[144:145], v24 offset:3584
    ds_read_b64_tr_b16 v[146:147], v24 offset:3808
    ds_read_b128 v[148:151], v57 offset:8192
    s_waitcnt lgkmcnt(12)
    v_mfma_f32_32x32x16_bf16 v[32:47], v[112:115], v[116:119], 0
    ds_read_b64_tr_b16 v[152:153], v24 offset:4480
    ds_read_b64_tr_b16 v[154:155], v24 offset:4704
    ds_read_b128 v[156:159], v58 offset:8192
    s_waitcnt lgkmcnt(12)
    v_mfma_f32_32x32x16_bf16 v[32:47], v[120:123], v[124:127], v[32:47]
    ds_read_b64_tr_b16 v[112:113], v24 offset:5376
    ds_read_b64_tr_b16 v[114:115], v24 offset:5600
    ds_read_b128 v[116:119], v59 offset:8192
    s_waitcnt lgkmcnt(12)
    v_mfma_f32_32x32x16_bf16 v[32:47], v[128:131], v[132:135], v[32:47]
    ds_read_b64_tr_b16 v[120:121], v24 offset:6272
    ds_read_b64_tr_b16 v[122:123], v24 offset:6496
    ds_read_b128 v[124:127], v60 offset:8192
    s_waitcnt lgkmcnt(12)
    v_mfma_f32_32x32x16_bf16 v[32:47], v[136:139], v[140:143], v[32:47]
    ds_read_b64_tr_b16 v[128:129], v24 offset:7168
    ds_read_b64_tr_b16 v[130:131], v24 offset:7392
    ds_read_b128 v[132:135], v57 offset:16384
    s_waitcnt lgkmcnt(12)
    v_mfma_f32_32x32x16_bf16 v[32:47], v[144:147], v[148:151], v[32:47]
    ds_read_b64_tr_b16 v[136:137], v24 offset:8064
    ds_read_b64_tr_b16 v[138:139], v24 offset:8288
    ds_read_b128 v[140:143], v58 offset:16384
    s_waitcnt lgkmcnt(12)
    v_mfma_f32_32x32x16_bf16 v[32:47], v[152:155], v[156:159], v[32:47]
    ds_read_b64_tr_b16 v[144:145], v24 offset:8960
    ds_read_b64_tr_b16 v[146:147], v24 offset:9184
    ds_read_b128 v[148:151], v59 offset:16384
    s_waitcnt lgkmcnt(12)
    v_mfma_f32_32x32x16_bf16 v[32:47], v[112:115], v[116:119], v[32:47]
    ds_read_b64_tr_b16 v[152:153], v24 offset:9856
    ds_read_b64_tr_b16 v[154:155], v24 offset:10080
    ds_read_b128 v[156:159], v60 offset:16384
    s_waitcnt lgkmcnt(12)
    v_mfma_f32_32x32x16_bf16 v[32:47], v[120:123], v[124:127], v[32:47]
    ds_read_b64_tr_b16 v[112:113], v24 offset:10752
    ds_read_b64_tr_b16 v[114:115], v24 offset:10976
    ds_read_b128 v[116:119], v57 offset:24576
    s_waitcnt lgkmcnt(12)
    v_mfma_f32_32x32x16_bf16 v[32:47], v[128:131], v[132:135], v[32:47]
    ds_read_b64_tr_b16 v[120:121], v24 offset:11648
    ds_read_b64_tr_b16 v[122:123], v24 offset:11872
    ds_read_b128 v[124:127], v58 offset:24576
    s_waitcnt lgkmcnt(12)
    v_mfma_f32_32x32x16_bf16 v[32:47], v[136:139], v[140:143], v[32:47]
    ds_read_b64_tr_b16 v[128:129], v24 offset:12544
    ds_read_b64_tr_b16 v[130:131], v24 offset:12768
    ds_read_b128 v[132:135], v59 offset:24576
    s_waitcnt lgkmcnt(12)
    v_mfma_f32_32x32x16_bf16 v[32:47], v[144:147], v[148:151], v[32:47]
    ds_read_b64_tr_b16 v[136:137], v24 offset:13440
    ds_read_b64_tr_b16 v[138:139], v24 offset:13664
    ds_read_b128 v[140:143], v60 offset:24576
    s_waitcnt lgkmcnt(12)
    v_mfma_f32_32x32x16_bf16 v[32:47], v[152:155], v[156:159], v[32:47]
    ds_read_b64_tr_b16 v[144:145], v24 offset:14336
    ds_read_b64_tr_b16 v[146:147], v24 offset:14560
    ds_read_b128 v[148:151], v57 offset:32768
    s_waitcnt lgkmcnt(12)
    v_mfma_f32_32x32x16_bf16 v[32:47], v[112:115], v[116:119], v[32:47]
    ds_read_b64_tr_b16 v[152:153], v24 offset:15232
    ds_read_b64_tr_b16 v[154:155], v24 offset:15456
    ds_read_b128 v[156:159], v58 offset:32768
    s_waitcnt lgkmcnt(12)
    v_mfma_f32_32x32x16_bf16 v[32:47], v[120:123], v[124:127], v[32:47]
    ds_read_b64_tr_b16 v[112:113], v24 offset:16128
    ds_read_b64_tr_b16 v[114:115], v24 offset:16352
    ds_read_b128 v[116:119], v59 offset:32768
    s_waitcnt lgkmcnt(12)
    v_mfma_f32_32x32x16_bf16 v[32:47], v[128:131], v[132:135], v[32:47]
    ds_read_b64_tr_b16 v[120:121], v24 offset:17024
    ds_read_b64_tr_b16 v[122:123], v24 offset:17248
    ds_read_b128 v[124:127], v60 offset:32768
    s_waitcnt lgkmcnt(12)
    v_mfma_f32_32x32x16_bf16 v[32:47], v[136:139], v[140:143], v[32:47]
    ds_read_b64_tr_b16 v[128:129], v24 offset:17920
    ds_read_b64_tr_b16 v[130:131], v24 offset:18144
    ds_read_b128 v[132:135], v57 offset:40960
    s_waitcnt lgkmcnt(12)
    v_mfma_f32_32x32x16_bf16 v[32:47], v[144:147], v[148:151], v[32:47]
    ds_read_b64_tr_b16 v[136:137], v24 offset:18816
    ds_read_b64_tr_b16 v[138:139], v24 offset:19040
    ds_read_b128 v[140:143], v58 offset:40960
    s_waitcnt lgkmcnt(12)
    v_mfma_f32_32x32x16_bf16 v[32:47], v[152:155], v[156:159], v[32:47]
    ds_read_b64_tr_b16 v[144:145], v24 offset:19712
    ds_read_b64_tr_b16 v[146:147], v24 offset:19936
    ds_read_b128 v[148:151], v59 offset:40960
    s_waitcnt lgkmcnt(12)
    v_mfma_f32_32x32x16_bf16 v[32:47], v[112:115], v[116:119], v[32:47]
    ds_read_b64_tr_b16 v[152:153], v24 offset:20608
    ds_read_b64_tr_b16 v[154:155], v24 offset:20832
    ds_read_b128 v[156:159], v60 offset:40960
    s_waitcnt lgkmcnt(12)
    v_mfma_f32_32x32x16_bf16 v[32:47], v[120:123], v[124:127], v[32:47]
    ds_read_b64_tr_b16 v[112:113], v24 offset:21504
    ds_read_b64_tr_b16 v[114:115], v24 offset:21728
    ds_read_b128 v[116:119], v57 offset:49152
    s_waitcnt lgkmcnt(12)
    v_mfma_f32_32x32x16_bf16 v[32:47], v[128:131], v[132:135], v[32:47]
    ds_read_b64_tr_b16 v[120:121], v24 offset:22400
    ds_read_b64_tr_b16 v[122:123], v24 offset:22624
    ds_read_b128 v[124:127], v58 offset:49152
    s_waitcnt lgkmcnt(12)
    v_mfma_f32_32x32x16_bf16 v[32:47], v[136:139], v[140:143], v[32:47]
    ds_read_b64_tr_b16 v[128:129], v24 offset:23296
    ds_read_b64_tr_b16 v[130:131], v24 offset:23520
    ds_read_b128 v[132:135], v59 offset:49152
    s_waitcnt lgkmcnt(12)
    v_mfma_f32_32x32x16_bf16 v[32:47], v[144:147], v[148:151], v[32:47]
    ds_read_b64_tr_b16 v[136:137], v24 offset:24192
    ds_read_b64_tr_b16 v[138:139], v24 offset:24416
    ds_read_b128 v[140:143], v60 offset:49152
    s_waitcnt lgkmcnt(12)
    v_mfma_f32_32x32x16_bf16 v[32:47], v[152:155], v[156:159], v[32:47]
    s_waitcnt lgkmcnt(9)
    v_mfma_f32_32x32x16_bf16 v[32:47], v[112:115], v[116:119], v[32:47]
    s_waitcnt lgkmcnt(6)
    v_mfma_f32_32x32x16_bf16 v[32:47], v[120:123], v[124:127], v[32:47]
    s_waitcnt lgkmcnt(3)
    v_mfma_f32_32x32x16_bf16 v[32:47], v[128:131], v[132:135], v[32:47]
    s_waitcnt lgkmcnt(0)
    v_mfma_f32_32x32x16_bf16 v[32:47], v[136:139], v[140:143], v[32:47]
    s_branch L_kvstore
L_vgemm:
    ds_read_b64_tr_b16 v[112:113], v24 offset:0
    ds_read_b64_tr_b16 v[114:115], v24 offset:224
    ds_read_b128 v[116:119], v57 offset:0
    ds_read_b64_tr_b16 v[120:121], v24 offset:896
    ds_read_b64_tr_b16 v[122:123], v24 offset:1120
    ds_read_b128 v[124:127], v58 offset:0
    ds_read_b64_tr_b16 v[128:129], v24 offset:1792
    ds_read_b64_tr_b16 v[130:131], v24 offset:2016
    ds_read_b128 v[132:135], v59 offset:0
    ds_read_b64_tr_b16 v[136:137], v24 offset:2688
    ds_read_b64_tr_b16 v[138:139], v24 offset:2912
    ds_read_b128 v[140:143], v60 offset:0
    ds_read_b64_tr_b16 v[144:145], v24 offset:3584
    ds_read_b64_tr_b16 v[146:147], v24 offset:3808
    ds_read_b128 v[148:151], v57 offset:8192
    s_waitcnt lgkmcnt(12)
    v_mfma_f32_32x32x16_bf16 v[32:47], v[116:119], v[112:115], 0
    ds_read_b64_tr_b16 v[152:153], v24 offset:4480
    ds_read_b64_tr_b16 v[154:155], v24 offset:4704
    ds_read_b128 v[156:159], v58 offset:8192
    s_waitcnt lgkmcnt(12)
    v_mfma_f32_32x32x16_bf16 v[32:47], v[124:127], v[120:123], v[32:47]
    ds_read_b64_tr_b16 v[112:113], v24 offset:5376
    ds_read_b64_tr_b16 v[114:115], v24 offset:5600
    ds_read_b128 v[116:119], v59 offset:8192
    s_waitcnt lgkmcnt(12)
    v_mfma_f32_32x32x16_bf16 v[32:47], v[132:135], v[128:131], v[32:47]
    ds_read_b64_tr_b16 v[120:121], v24 offset:6272
    ds_read_b64_tr_b16 v[122:123], v24 offset:6496
    ds_read_b128 v[124:127], v60 offset:8192
    s_waitcnt lgkmcnt(12)
    v_mfma_f32_32x32x16_bf16 v[32:47], v[140:143], v[136:139], v[32:47]
    ds_read_b64_tr_b16 v[128:129], v24 offset:7168
    ds_read_b64_tr_b16 v[130:131], v24 offset:7392
    ds_read_b128 v[132:135], v57 offset:16384
    s_waitcnt lgkmcnt(12)
    v_mfma_f32_32x32x16_bf16 v[32:47], v[148:151], v[144:147], v[32:47]
    ds_read_b64_tr_b16 v[136:137], v24 offset:8064
    ds_read_b64_tr_b16 v[138:139], v24 offset:8288
    ds_read_b128 v[140:143], v58 offset:16384
    s_waitcnt lgkmcnt(12)
    v_mfma_f32_32x32x16_bf16 v[32:47], v[156:159], v[152:155], v[32:47]
    ds_read_b64_tr_b16 v[144:145], v24 offset:8960
    ds_read_b64_tr_b16 v[146:147], v24 offset:9184
    ds_read_b128 v[148:151], v59 offset:16384
    s_waitcnt lgkmcnt(12)
    v_mfma_f32_32x32x16_bf16 v[32:47], v[116:119], v[112:115], v[32:47]
    ds_read_b64_tr_b16 v[152:153], v24 offset:9856
    ds_read_b64_tr_b16 v[154:155], v24 offset:10080
    ds_read_b128 v[156:159], v60 offset:16384
    s_waitcnt lgkmcnt(12)
    v_mfma_f32_32x32x16_bf16 v[32:47], v[124:127], v[120:123], v[32:47]
    ds_read_b64_tr_b16 v[112:113], v24 offset:10752
    ds_read_b64_tr_b16 v[114:115], v24 offset:10976
    ds_read_b128 v[116:119], v57 offset:24576
    s_waitcnt lgkmcnt(12)
    v_mfma_f32_32x32x16_bf16 v[32:47], v[132:135], v[128:131], v[32:47]
    ds_read_b64_tr_b16 v[120:121], v24 offset:11648
    ds_read_b64_tr_b16 v[122:123], v24 offset:11872
    ds_read_b128 v[124:127], v58 offset:24576
    s_waitcnt lgkmcnt(12)
    v_mfma_f32_32x32x16_bf16 v[32:47], v[140:143], v[136:139], v[32:47]
    ds_read_b64_tr_b16 v[128:129], v24 offset:12544
    ds_read_b64_tr_b16 v[130:131], v24 offset:12768
    ds_read_b128 v[132:135], v59 offset:24576
    s_waitcnt lgkmcnt(12)
    v_mfma_f32_32x32x16_bf16 v[32:47], v[148:151], v[144:147], v[32:47]
    ds_read_b64_tr_b16 v[136:137], v24 offset:13440
    ds_read_b64_tr_b16 v[138:139], v24 offset:13664
    ds_read_b128 v[140:143], v60 offset:24576
    s_waitcnt lgkmcnt(12)
    v_mfma_f32_32x32x16_bf16 v[32:47], v[156:159], v[152:155], v[32:47]
    ds_read_b64_tr_b16 v[144:145], v24 offset:14336
    ds_read_b64_tr_b16 v[146:147], v24 offset:14560
    ds_read_b128 v[148:151], v57 offset:32768
    s_waitcnt lgkmcnt(12)
    v_mfma_f32_32x32x16_bf16 v[32:47], v[116:119], v[112:115], v[32:47]
    ds_read_b64_tr_b16 v[152:153], v24 offset:15232
    ds_read_b64_tr_b16 v[154:155], v24 offset:15456
    ds_read_b128 v[156:159], v58 offset:32768
    s_waitcnt lgkmcnt(12)
    v_mfma_f32_32x32x16_bf16 v[32:47], v[124:127], v[120:123], v[32:47]
    ds_read_b64_tr_b16 v[112:113], v24 offset:16128
    ds_read_b64_tr_b16 v[114:115], v24 offset:16352
    ds_read_b128 v[116:119], v59 offset:32768
    s_waitcnt lgkmcnt(12)
    v_mfma_f32_32x32x16_bf16 v[32:47], v[132:135], v[128:131], v[32:47]
    ds_read_b64_tr_b16 v[120:121], v24 offset:17024
    ds_read_b64_tr_b16 v[122:123], v24 offset:17248
    ds_read_b128 v[124:127], v60 offset:32768
    s_waitcnt lgkmcnt(12)
    v_mfma_f32_32x32x16_bf16 v[32:47], v[140:143], v[136:139], v[32:47]
    ds_read_b64_tr_b16 v[128:129], v24 offset:17920
    ds_read_b64_tr_b16 v[130:131], v24 offset:18144
    ds_read_b128 v[132:135], v57 offset:40960
    s_waitcnt lgkmcnt(12)
    v_mfma_f32_32x32x16_bf16 v[32:47], v[148:151], v[144:147], v[32:47]
    ds_read_b64_tr_b16 v[136:137], v24 offset:18816
    ds_read_b64_tr_b16 v[138:139], v24 offset:19040
    ds_read_b128 v[140:143], v58 offset:40960
    s_waitcnt lgkmcnt(12)
    v_mfma_f32_32x32x16_bf16 v[32:47], v[156:159], v[152:155], v[32:47]
    ds_read_b64_tr_b16 v[144:145], v24 offset:19712
    ds_read_b64_tr_b16 v[146:147], v24 offset:19936
    ds_read_b128 v[148:151], v59 offset:40960
    s_waitcnt lgkmcnt(12)
    v_mfma_f32_32x32x16_bf16 v[32:47], v[116:119], v[112:115], v[32:47]
    ds_read_b64_tr_b16 v[152:153], v24 offset:20608
    ds_read_b64_tr_b16 v[154:155], v24 offset:20832
    ds_read_b128 v[156:159], v60 offset:40960
    s_waitcnt lgkmcnt(12)
    v_mfma_f32_32x32x16_bf16 v[32:47], v[124:127], v[120:123], v[32:47]
    ds_read_b64_tr_b16 v[112:113], v24 offset:21504
    ds_read_b64_tr_b16 v[114:115], v24 offset:21728
    ds_read_b128 v[116:119], v57 offset:49152
    s_waitcnt lgkmcnt(12)
    v_mfma_f32_32x32x16_bf16 v[32:47], v[132:135], v[128:131], v[32:47]
    ds_read_b64_tr_b16 v[120:121], v24 offset:22400
    ds_read_b64_tr_b16 v[122:123], v24 offset:22624
    ds_read_b128 v[124:127], v58 offset:49152
    s_waitcnt lgkmcnt(12)
    v_mfma_f32_32x32x16_bf16 v[32:47], v[140:143], v[136:139], v[32:47]
    ds_read_b64_tr_b16 v[128:129], v24 offset:23296
    ds_read_b64_tr_b16 v[130:131], v24 offset:23520
    ds_read_b128 v[132:135], v59 offset:49152
    s_waitcnt lgkmcnt(12)
    v_mfma_f32_32x32x16_bf16 v[32:47], v[148:151], v[144:147], v[32:47]
    ds_read_b64_tr_b16 v[136:137], v24 offset:24192
    ds_read_b64_tr_b16 v[138:139], v24 offset:24416
    ds_read_b128 v[140:143], v60 offset:49152
    s_waitcnt lgkmcnt(12)
    v_mfma_f32_32x32x16_bf16 v[32:47], v[156:159], v[152:155], v[32:47]
    s_waitcnt lgkmcnt(9)
    v_mfma_f32_32x32x16_bf16 v[32:47], v[116:119], v[112:115], v[32:47]
    s_waitcnt lgkmcnt(6)
    v_mfma_f32_32x32x16_bf16 v[32:47], v[124:127], v[120:123], v[32:47]
    s_waitcnt lgkmcnt(3)
    v_mfma_f32_32x32x16_bf16 v[32:47], v[132:135], v[128:131], v[32:47]
    s_waitcnt lgkmcnt(0)
    v_mfma_f32_32x32x16_bf16 v[32:47], v[140:143], v[136:139], v[32:47]
L_kvstore:
    s_nop 7
    s_nop 3
    s_bitcmp1_b32 s60, 0
    s_cselect_b32 s66, 1.0, 0x3e8b97f6
    v_and_b32 v32, v26, v32
    v_mul_f32 v32, s66, v32
    v_and_b32 v33, v26, v33
    v_mul_f32 v33, s66, v33
    v_and_b32 v34, v26, v34
    v_mul_f32 v34, s66, v34
    v_and_b32 v35, v26, v35
    v_mul_f32 v35, s66, v35
    v_and_b32 v36, v26, v36
    v_mul_f32 v36, s66, v36
    v_and_b32 v37, v26, v37
    v_mul_f32 v37, s66, v37
    v_and_b32 v38, v26, v38
    v_mul_f32 v38, s66, v38
    v_and_b32 v39, v26, v39
    v_mul_f32 v39, s66, v39
    v_and_b32 v40, v26, v40
    v_mul_f32 v40, s66, v40
    v_and_b32 v41, v26, v41
    v_mul_f32 v41, s66, v41
    v_and_b32 v42, v26, v42
    v_mul_f32 v42, s66, v42
    v_and_b32 v43, v26, v43
    v_mul_f32 v43, s66, v43
    v_and_b32 v44, v27, v44
    v_mul_f32 v44, s66, v44
    v_and_b32 v45, v27, v45
    v_mul_f32 v45, s66, v45
    v_and_b32 v46, v27, v46
    v_mul_f32 v46, s66, v46
    v_and_b32 v47, v27, v47
    v_mul_f32 v47, s66, v47
    v_cvt_pk_bf16_f32 v48, v32, v33
    v_cvt_pk_bf16_f32 v49, v34, v35
    v_cvt_pk_bf16_f32 v50, v36, v37
    v_cvt_pk_bf16_f32 v51, v38, v39
    v_cvt_pk_bf16_f32 v52, v40, v41
    v_cvt_pk_bf16_f32 v53, v42, v43
    v_cvt_pk_bf16_f32 v54, v44, v45
    v_cvt_pk_bf16_f32 v55, v46, v47
    v_or_b32 v48, v48, v28
    v_or_b32 v49, v49, v28
    v_or_b32 v50, v50, v28
    v_or_b32 v51, v51, v28
    v_or_b32 v52, v52, v28
    v_or_b32 v53, v53, v28
    v_or_b32 v54, v54, v28
    v_or_b32 v55, v55, v28
    s_nop 0
    v_permlane32_swap_b32 v48, v50
    v_permlane32_swap_b32 v49, v51
    v_permlane32_swap_b32 v52, v54
    v_permlane32_swap_b32 v53, v55
    buffer_store_dwordx4 v[48:51], v25, s[44:47], 0 offen sc1
    buffer_store_dwordx4 v[52:55], v25, s[44:47], 0 offen offset:1024 sc1
    v_mul_f32 v16, v32, v32
    v_fmac_f32 v16, v33, v33
    v_fmac_f32 v16, v34, v34
    v_fmac_f32 v16, v35, v35
    v_mul_f32 v17, v36, v36
    v_fmac_f32 v17, v37, v37
    v_fmac_f32 v17, v38, v38
    v_fmac_f32 v17, v39, v39
    v_mul_f32 v18, v40, v40
    v_fmac_f32 v18, v41, v41
    v_fmac_f32 v18, v42, v42
    v_fmac_f32 v18, v43, v43
    v_mul_f32 v19, v44, v44
    v_fmac_f32 v19, v45, v45
    v_fmac_f32 v19, v46, v46
    v_fmac_f32 v19, v47, v47
    v_max3_u32 v16, v16, v17, v18
    v_max_u32 v16, v16, v19
    s_nop 1
    v_max_u32_dpp v16, v16, v16 quad_perm:[1,0,3,2] row_mask:0xf bank_mask:0xf
    s_nop 1
    v_max_u32_dpp v16, v16, v16 quad_perm:[2,3,0,1] row_mask:0xf bank_mask:0xf
    s_nop 1
    v_max_u32_dpp v16, v16, v16 row_half_mirror row_mask:0xf bank_mask:0xf
    s_nop 1
    v_max_u32_dpp v16, v16, v16 row_mirror row_mask:0xf bank_mask:0xf
    v_mov_b32 v17, v16
    s_nop 1
    v_permlane16_swap_b32 v16, v17
    v_max_u32 v16, v16, v17
    v_mov_b32 v17, v16
    s_nop 1
    v_permlane32_swap_b32 v16, v17
    v_max_u32 v16, v16, v17
    s_mov_b64 exec, 1
    ds_max_u32 v29, v16
    s_mov_b64 exec, -1
    s_waitcnt vmcnt(0) lgkmcnt(0)
L_kv_v:
    s_barrier
    s_cmp_eq_u32 s60, 0
    s_cbranch_scc0 L_nofb
    ds_read_b64 v[50:51], v31 offset:8
    ds_read_b32 v49, v31 offset:4
    v_mov_b32 v48, s63
    s_waitcnt lgkmcnt(0)
    s_mov_b64 exec, 0xff
    buffer_store_dwordx3 v[48:50], v63, s[44:47], 0 offen sc1
    s_mov_b64 exec, -1
L_nofb:
    s_branch L_noconv
L_vpath:
    s_setprio 3
    s_lshl_b32 s69, s62, 7
    v_mul_u32_u24 v5, 896, v2
    v_lshl_add_u32 v5, v3, 4, v5
    s_lshl_b32 s66, s95, 1
    s_mul_i32 s70, s66, 1056
    s_mul_i32 s66, s66, 7168
    s_add_u32 s67, s65, s69
    s_add_u32 s66, s67, s66
    v_add_u32 v33, s66, v5
    v_subrev_u32 v32, 2688, v33
    v_add_u32 v35, 4480, v33
    s_add_u32 s67, s67, 54656
    v_add_u32 v36, s67, v5
    s_lshl_b32 s66, s95, 3
    v_add_u32 v4, s66, v3
    s_lshl_b32 s67, s62, 9
    v_lshlrev_b32 v6, 4, v4
    v_add_u32 v34, s67, v6
    s_movk_i32 s71, 7168
    s_waitcnt lgkmcnt(0)
    s_barrier
    s_add_u32 m0, s70, 66560
    s_nop 0
    buffer_load_dwordx4 v32, s[8:11], 0 offen lds
    s_add_u32 m0, s70, 67616
    s_nop 0
    buffer_load_dwordx4 v35, s[8:11], 0 offen lds
    s_add_u32 m0, s70, 76064
    s_nop 0
    buffer_load_dwordx4 v33, s[12:15], 0 offen lds
    s_add_u32 m0, s70, 77120
    s_nop 0
    buffer_load_dwordx4 v33, s[12:15], s71 offen lds
    buffer_load_dwordx4 v[52:55], v34, s[16:19], 0 offen
    s_mov_b32 m0, 75008
    s_mov_b64 exec, 0xffffff
    buffer_load_dwordx4 v36, s[8:11], 0 offen lds
    s_mov_b64 exec, -1
    s_load_dwordx2 s[44:45], s[0:1], 104
    s_load_dwordx2 s[20:21], s[0:1], 32
    s_load_dwordx2 s[88:89], s[0:1], 40
    s_load_dwordx2 s[4:5], s[0:1], 0
    s_load_dwordx2 s[36:37], s[0:1], 80
    s_load_dwordx2 s[40:41], s[0:1], 88
    s_lshl_b32 s66, s95, 3
    v_add_u32 v4, s66, v3
    v_mul_u32_u24 v5, 1056, v2
    v_lshl_add_u32 v5, v4, 2, v5
    v_add_u32 v62, 66560, v5
    v_mul_u32_u24 v5, 144, v4
    v_lshl_add_u32 v5, v2, 4, v5
    v_add_u32 v24, 57344, v5
    v_add_u32 v4, s66, v2
    v_mul_u32_u24 v5, 144, v4
    v_lshl_add_u32 v5, v3, 4, v5
    v_add_u32 v25, 57344, v5
    v_lshlrev_b32 v5, 13, v4
    v_lshl_add_u32 v5, v3, 4, v5
    s_lshl_b32 s66, s62, 18
    s_lshl_b32 s67, s61, 7
    s_add_u32 s66, s66, s67
    s_add_u32 s66, s66, 393216
    v_add_u32 v26, s66, v5
    v_and_b32 v5, 31, v1
    v_lshlrev_b32 v5, 4, v5
    v_lshrrev_b32 v4, 5, v1
    v_mul_u32_u24 v4, 4608, v4
    v_add_u32 v4, v4, v5
    v_add_u32 v4, 149248, v4
    v_mov_b32 v112, 0
    v_mov_b32 v113, 0
    v_mov_b32 v114, 0
    v_mov_b32 v115, 0
    s_waitcnt lgkmcnt(0)
    ds_write_b128 v4, v[112:115]
    s_min_u32 s66, s48, 223
    s_lshl_b32 s66, s66, 2
    s_load_dword s63, s[44:45], 0
    s_load_dword s64, s[88:89], s66
    s_setprio 3
    s_waitcnt lgkmcnt(0)
    s_mul_i32 s63, s63, 0x9E3779B1
    s_add_u32 s63, s63, 0x7F4A7C15
    s_lshl_b32 s66, s64, 16
    s_and_b32 s64, s64, 0xffff0000
    s_cmp_eq_u32 s101, 0
    s_cselect_b32 s64, s66, s64
    s_movk_i32 s70, 4096
    s_mul_i32 s66, s61, 1792
    s_lshl_b32 s67, s62, 8
    s_add_u32 s66, s66, s67
    s_lshl_b32 s67, s95, 6
    s_add_u32 s66, s66, s67
    s_add_u32 s66, s66, 6291456
    v_and_b32 v60, 0x38, v1
    v_add_u32 v60, s66, v60
    v_and_b32 v56, 7, v1
    v_lshlrev_b32 v56, 2, v56
    v_add_u32 v57, 1, v56
    v_add_u32 v58, 2, v56
    v_add_u32 v59, 3, v56
    s_waitcnt vmcnt(0)
    s_mov_b64 exec, 1
    ds_add_u32 v31, v30 offset:36
    s_mov_b64 exec, -1
    v_lshlrev_b32 v150, 16, v52
    v_lshlrev_b32 v151, 16, v54
    v_and_b32 v152, 0xffff0000, v52
    v_and_b32 v153, 0xffff0000, v54
    v_lshlrev_b32 v154, 16, v53
    v_lshlrev_b32 v155, 16, v55
    v_and_b32 v156, 0xffff0000, v53
    v_and_b32 v157, 0xffff0000, v55
    v_add_u32 v16, 1056, v62
    v_add_u32 v17, 9504, v62
    v_mov_b32 v19, s63
L_vs1:
    ds_read_b32 v18, v31 offset:36
    s_waitcnt lgkmcnt(0)
    v_cmp_gt_u32 vcc, 4, v18
    s_cbranch_vccnz L_vs1
    ds_read2_b32 v[32:33], v62 offset0:0 offset1:32
    ds_read2_b32 v[34:35], v62 offset0:64 offset1:96
    ds_read2_b32 v[36:37], v62 offset0:128 offset1:160
    ds_read2_b32 v[38:39], v62 offset0:192 offset1:224
    ds_read2_b32 v[40:41], v16 offset0:0 offset1:32
    ds_read_b32 v42, v16 offset:256
    ds_read2_b32 v[44:45], v17 offset0:0 offset1:32
    ds_read2_b32 v[46:47], v17 offset0:64 offset1:96
    ds_read2_b32 v[48:49], v17 offset0:128 offset1:160
    ds_read2_b32 v[50:51], v17 offset0:192 offset1:224
    s_waitcnt lgkmcnt(8)
    v_lshlrev_b32 v112, 16, v32
    v_and_b32 v113, 0xffff0000, v32
    v_lshlrev_b32 v114, 16, v33
    v_and_b32 v115, 0xffff0000, v33
    v_lshlrev_b32 v116, 16, v34
    v_and_b32 v117, 0xffff0000, v34
    v_lshlrev_b32 v118, 16, v35
    v_and_b32 v119, 0xffff0000, v35
    s_waitcnt lgkmcnt(4)
    v_lshlrev_b32 v120, 16, v36
    v_and_b32 v121, 0xffff0000, v36
    v_lshlrev_b32 v122, 16, v37
    v_and_b32 v123, 0xffff0000, v37
    v_lshlrev_b32 v124, 16, v38
    v_and_b32 v125, 0xffff0000, v38
    v_lshlrev_b32 v126, 16, v39
    v_and_b32 v127, 0xffff0000, v39
    v_lshlrev_b32 v128, 16, v40
    v_and_b32 v129, 0xffff0000, v40
    v_lshlrev_b32 v130, 16, v41
    v_and_b32 v131, 0xffff0000, v41
    v_lshlrev_b32 v132, 16, v42
    v_and_b32 v133, 0xffff0000, v42
    v_pk_mul_f32 v[158:159], v[112:113], v[156:157]
    v_pk_mul_f32 v[160:161], v[114:115], v[156:157]
    v_pk_mul_f32 v[162:163], v[116:117], v[156:157]
    v_pk_mul_f32 v[164:165], v[118:119], v[156:157]
    v_pk_mul_f32 v[166:167], v[120:121], v[156:157]
    v_pk_mul_f32 v[168:169], v[122:123], v[156:157]
    v_pk_mul_f32 v[170:171], v[124:125], v[156:157]
    v_pk_mul_f32 v[172:173], v[126:127], v[156:157]
    v_pk_fma_f32 v[158:159], v[114:115], v[154:155], v[158:159]
    v_pk_fma_f32 v[160:161], v[116:117], v[154:155], v[160:161]
    v_pk_fma_f32 v[162:163], v[118:119], v[154:155], v[162:163]
    v_pk_fma_f32 v[164:165], v[120:121], v[154:155], v[164:165]
    v_pk_fma_f32 v[166:167], v[122:123], v[154:155], v[166:167]
    v_pk_fma_f32 v[168:169], v[124:125], v[154:155], v[168:169]
    v_pk_fma_f32 v[170:171], v[126:127], v[154:155], v[170:171]
    v_pk_fma_f32 v[172:173], v[128:129], v[154:155], v[172:173]
    v_pk_fma_f32 v[158:159], v[116:117], v[152:153], v[158:159]
    v_pk_fma_f32 v[160:161], v[118:119], v[152:153], v[160:161]
    v_pk_fma_f32 v[162:163], v[120:121], v[152:153], v[162:163]
    v_pk_fma_f32 v[164:165], v[122:123], v[152:153], v[164:165]
    v_pk_fma_f32 v[166:167], v[124:125], v[152:153], v[166:167]
    v_pk_fma_f32 v[168:169], v[126:127], v[152:153], v[168:169]
    v_pk_fma_f32 v[170:171], v[128:129], v[152:153], v[170:171]
    v_pk_fma_f32 v[172:173], v[130:131], v[152:153], v[172:173]
    v_pk_fma_f32 v[158:159], v[118:119], v[150:151], v[158:159]
    v_pk_fma_f32 v[160:161], v[120:121], v[150:151], v[160:161]
    v_pk_fma_f32 v[162:163], v[122:123], v[150:151], v[162:163]
    v_pk_fma_f32 v[164:165], v[124:125], v[150:151], v[164:165]
    v_pk_fma_f32 v[166:167], v[126:127], v[150:151], v[166:167]
    v_pk_fma_f32 v[168:169], v[128:129], v[150:151], v[168:169]
    v_pk_fma_f32 v[170:171], v[130:131], v[150:151], v[170:171]
    v_pk_fma_f32 v[172:173], v[132:133], v[150:151], v[172:173]
    s_waitcnt lgkmcnt(0)
    v_lshlrev_b32 v134, 16, v44
    v_and_b32 v135, 0xffff0000, v44
    v_lshlrev_b32 v136, 16, v45
    v_and_b32 v137, 0xffff0000, v45
    v_lshlrev_b32 v138, 16, v46
    v_and_b32 v139, 0xffff0000, v46
    v_lshlrev_b32 v140, 16, v47
    v_and_b32 v141, 0xffff0000, v47
    v_lshlrev_b32 v142, 16, v48
    v_and_b32 v143, 0xffff0000, v48
    v_lshlrev_b32 v144, 16, v49
    v_and_b32 v145, 0xffff0000, v49
    v_lshlrev_b32 v146, 16, v50
    v_and_b32 v147, 0xffff0000, v50
    v_lshlrev_b32 v148, 16, v51
    v_and_b32 v149, 0xffff0000, v51
    v_pk_mul_f32 v[158:159], v[158:159], v[134:135]
    v_pk_mul_f32 v[160:161], v[160:161], v[136:137]
    v_pk_mul_f32 v[162:163], v[162:163], v[138:139]
    v_pk_mul_f32 v[164:165], v[164:165], v[140:141]
    v_pk_mul_f32 v[166:167], v[166:167], v[142:143]
    v_pk_mul_f32 v[168:169], v[168:169], v[144:145]
    v_pk_mul_f32 v[170:171], v[170:171], v[146:147]
    v_pk_mul_f32 v[172:173], v[172:173], v[148:149]
    v_cvt_pk_bf16_f32 v174, v172, v170
    v_cvt_pk_bf16_f32 v175, v168, v166
    v_cvt_pk_bf16_f32 v176, v164, v162
    v_cvt_pk_bf16_f32 v177, v160, v158
    ds_write_b128 v24, v[174:177]
    v_cvt_pk_bf16_f32 v178, v173, v171
    v_cvt_pk_bf16_f32 v179, v169, v167
    v_cvt_pk_bf16_f32 v180, v165, v163
    v_cvt_pk_bf16_f32 v181, v161, v159
    ds_write_b128 v24, v[178:181] offset:4608
    s_waitcnt lgkmcnt(1)
    ds_read_b128 v[182:185], v25
    s_waitcnt lgkmcnt(1)
    ds_read_b128 v[186:189], v25 offset:4608
    s_waitcnt lgkmcnt(1)
    buffer_store_dwordx4 v[182:185], v26, s[44:47], 0 offen sc1
    s_waitcnt lgkmcnt(0)
    buffer_store_dwordx4 v[186:189], v26, s[44:47], s70 offen sc1
    v_alignbit_b32 v174, v182, v182, v56
    v_alignbit_b32 v175, v183, v183, v57
    v_alignbit_b32 v176, v184, v184, v58
    v_alignbit_b32 v177, v185, v185, v59
    v_alignbit_b32 v178, v186, v186, v56
    v_alignbit_b32 v179, v187, v187, v57
    v_alignbit_b32 v180, v188, v188, v58
    v_alignbit_b32 v181, v189, v189, v59
    v_add3_u32 v174, v174, v175, v176
    v_add_u32 v174, v174, v177
    v_add3_u32 v178, v178, v179, v180
    v_add_u32 v178, v178, v181
    s_nop 0
    v_add_u32_dpp v174, v174, v174 quad_perm:[1,0,3,2] row_mask:0xf bank_mask:0xf
    v_add_u32_dpp v178, v178, v178 quad_perm:[1,0,3,2] row_mask:0xf bank_mask:0xf
    s_nop 0
    v_add_u32_dpp v174, v174, v174 quad_perm:[2,3,0,1] row_mask:0xf bank_mask:0xf
    v_add_u32_dpp v178, v178, v178 quad_perm:[2,3,0,1] row_mask:0xf bank_mask:0xf
    s_nop 0
    v_add_u32_dpp v174, v174, v174 row_half_mirror row_mask:0xf bank_mask:0xf
    v_add_u32_dpp v178, v178, v178 row_half_mirror row_mask:0xf bank_mask:0xf
    v_add_u32 v174, s63, v174
    v_add_u32 v178, s63, v178
    v_mov_b32 v175, v178
    s_mov_b32 exec_lo, 0x01010101
    s_mov_b32 exec_hi, 0x01010101
    buffer_store_dwordx2 v[174:175], v60, s[44:47], 0 offen sc1
    s_mov_b64 exec, -1
    s_setprio 0
    s_mov_b64 exec, 1
    ds_add_u32 v31, v30 offset:48
    s_mov_b64 exec, -1
    v_lshrrev_b32 v16, 3, v1
    v_lshrrev_b32 v17, 1, v16
    s_and_b32 s66, s60, 1
    s_lshl_b32 s66, s66, 2
    v_xor_b32 v17, v17, v1
    v_xor_b32 v17, s66, v17
    v_and_b32 v17, 7, v17
    s_lshl_b32 s66, s60, 3
    v_add_u32 v16, s66, v16
    v_mul_u32_u24 v16, 896, v16
    v_lshl_add_u32 v16, v17, 4, v16
    v_add_u32 v243, s65, v16
    s_lshl_b32 s57, s60, 10
    s_add_u32 m0, s57, 0
    s_nop 0
    buffer_load_dwordx4 v243, s[24:27], 0 offen offset:0 lds
    s_add_u32 m0, s57, 8064
    s_nop 0
    buffer_load_dwordx4 v243, s[24:27], 0 offen offset:128 lds
    s_add_u32 m0, s57, 16128
    s_nop 0
    buffer_load_dwordx4 v243, s[24:27], 0 offen offset:256 lds
    s_add_u32 m0, s57, 24192
    s_nop 0
    buffer_load_dwordx4 v243, s[24:27], 0 offen offset:384 lds
    v_lshlrev_b32 v16, 4, v1
    s_lshl_b32 s66, s101, 14
    v_add_u32 v96, s66, v16
    v_lshlrev_b32 v111, 1, v96
    v_add_u32 v111, 57344, v111
    v_add_u32 v96, 57344, v96
    s_lshl_b32 s67, s95, 11
    s_add_u32 s100, s66, s67
    s_lshl_b32 s3, s100, 1
    s_add_u32 s3, s3, 57344
    s_add_u32 s100, s100, 57344
    s_lshl_b32 s66, s101, 16
    s_add_u32 s68, s66, 65536
    v_add_u32 v250, s68, v16
    s_add_u32 s66, s66, s67
    s_add_u32 s68, s66, 67584
    v_add_u32 v97, s68, v16
    s_add_u32 s68, s66, 196608
    v_add_u32 v99, s68, v16
    v_mov_b32 v98, 0xdddddddd
    s_lshl_b32 s66, s61, 16
    s_lshl_b32 s67, s62, 13
    s_add_u32 s66, s66, s67
    s_add_u32 s66, s66, 4194304
    s_lshl_b32 s67, s60, 10
    s_add_u32 s67, s66, s67
    v_add_u32 v251, s67, v16
    s_and_b32 s67, s60, 1
    s_lshl_b32 s67, s67, 12
    s_add_u32 s66, s66, s67
    s_bfe_u32 s67, s60, 0x10001
    s_lshl_b32 s67, s67, 11
    s_add_u32 s66, s66, s67
    s_lshl_b32 s67, s101, 9
    s_add_u32 s66, s66, s67
    v_bfe_u32 v21, v1, 4, 1
    v_lshlrev_b32 v20, 1, v21
    v_lshlrev_b32 v17, 10, v21
    v_lshrrev_b32 v18, 5, v1
    v_lshl_add_u32 v17, v18, 8, v17
    v_and_b32 v19, 15, v1
    v_lshl_add_u32 v17, v19, 4, v17
    v_add_u32 v108, s66, v17
    s_mul_i32 s66, s60, 3072
    s_add_u32 s66, s66, 32768
    v_add_u32 v248, s66, v16
    s_xor_b32 s67, s60, 4
    s_mul_i32 s67, s67, 3072
    s_add_u32 s67, s67, 32768
    v_add_u32 v249, s67, v16
    v_lshlrev_b32 v17, 5, v19
    v_lshl_add_u32 v17, v18, 4, v17
    v_lshlrev_b32 v21, 3, v21
    s_mul_i32 s66, s101, 8192
    s_add_u32 s66, s66, 141056
    s_lshl_b32 s67, s95, 11
    s_add_u32 s68, s66, s67
    v_add_u32 v104, s68, v16
    s_xor_b32 s67, s67, 4096
    s_add_u32 s66, s66, s67
    v_add_u32 v105, s66, v16
    v_add3_u32 v106, v17, v21, s66
    v_sub_u32 v17, v17, v21
    s_and_b32 s67, s60, 1
    s_bfe_u32 s68, s60, 0x10001
    s_lshl_b32 s68, s68, 2
    s_add_u32 s68, s68, s67
    s_lshl_b32 s68, s68, 9
    s_mul_i32 s66, s101, 4608
    s_add_u32 s66, s66, s68
    s_add_u32 s66, s66, 149768
    v_add_u32 v240, s66, v17
    s_lshl_b32 s67, s67, 10
    s_sub_u32 s67, 1536, s67
    v_mul_lo_u32 v17, v18, s67
    v_and_b32 v22, 31, v1
    v_lshlrev_b32 v22, 4, v22
    s_lshl_b32 s66, s48, 13
    s_lshl_b32 s67, s101, 12
    s_add_u32 s66, s66, s67
    s_add_u32 s66, s66, s68
    s_add_u32 s66, s66, 2228224
    v_add3_u32 v107, v17, v22, s66
    s_min_u32 s69, s48, 223
    s_and_b32 s66, s2, 7
    s_lshl_b32 s66, s66, 12
    s_add_u32 s66, s66, 9502720
    v_add_u32 v242, s66, v22
    s_lshl_b32 s66, s69, 13
    s_lshl_b32 s67, s60, 10
    s_add_u32 s66, s66, s67
    s_add_u32 s66, s66, 393216
    v_add_u32 v255, s66, v16
    s_lshl_b32 s66, s101, 9
    s_add_u32 s66, s66, s67
    s_add_u32 s66, s66, 149760
    v_add_u32 v254, s66, v16
    v_lshrrev_b32 v21, 3, v1
    v_lshlrev_b32 v17, 2, v21
    v_add_u32 v17, s95, v17
    v_mul_u32_u24 v17, 896, v17
    v_xor_b32 v20, v20, v1
    v_and_b32 v20, 7, v20
    v_lshl_add_u32 v17, v20, 4, v17
    s_min_u32 s68, s62, 6
    s_lshl_b32 s69, s68, 7
    v_add_u32 v252, s69, v17
    s_mul_i32 s50, s101, 200704
    s_mul_i32 s94, s95, 14400
    s_mul_i32 s66, s101, 7168
    s_add_u32 s94, s94, s66
    s_add_u32 s94, s94, 90624
    v_and_b32 v20, 7, v1
    s_lshl_b32 s66, s68, 5
    v_add_u32 v17, s66, v1
    v_lshlrev_b32 v22, 5, v20
    v_cmp_gt_u32 vcc, 32, v1
    v_add_u32 v22, s61, v22
    s_nop 0
    v_cndmask_b32 v17, v22, v17, vcc
    v_lshlrev_b32 v17, 7, v17
    v_add_u32 v4, 9568256, v17
    s_lshl_b32 s66, s60, 3
    v_add_u32 v17, s66, v21
    v_lshlrev_b32 v22, 4, v20
    v_lshl_add_u32 v23, v17, 12, v22
    s_lshl_b32 s66, s61, 7
    s_lshl_b32 s67, s68, 18
    s_add_u32 s66, s66, s67
    s_add_u32 s66, s66, 2228224
    v_add_u32 v5, s66, v23
    v_mul_u32_u24 v17, 896, v17
    v_add_u32 v17, s65, v17
    v_add_u32 v22, s69, v22
    v_add_u32 v6, v17, v22
    v_lshl_add_u32 v110, v17, 1, v22
    v_xor_b32 v22, s60, v20
    v_lshlrev_b32 v22, 4, v22
    v_lshl_add_u32 v23, v21, 7, v22
    s_lshl_b32 s68, s60, 10
    s_add_u32 s68, s68, 149248
    v_add_u32 v7, s68, v23
    v_lshl_add_u32 v22, v20, 10, v22
    v_lshl_add_u32 v22, v21, 1, v22
    v_add_u32 v109, 149248, v22
    v_lshrrev_b32 v18, 4, v1
    v_mul_u32_u24 v22, 14400, v18
    v_lshl_add_u32 v22, v19, 2, v22
    v_add_u32 v253, 104960, v22
    v_mov_b32 v100, -1
    v_mov_b32 v101, -1
    v_mov_b32 v102, -1
    v_mov_b32 v103, -1
    v_mov_b32 v80, 0
    v_mov_b32 v81, 0
    v_mov_b32 v82, 0
    v_mov_b32 v83, 0
    v_mov_b32 v84, 0
    v_mov_b32 v85, 0
    v_mov_b32 v86, 0
    v_mov_b32 v87, 0
    v_mov_b32 v88, 0
    v_mov_b32 v89, 0
    v_mov_b32 v90, 0
    v_mov_b32 v91, 0
    v_mov_b32 v92, 0
    v_mov_b32 v93, 0
    v_mov_b32 v94, 0
    v_mov_b32 v95, 0
    v_mov_b32 v64, 0
    v_mov_b32 v65, 0
    v_mov_b32 v66, 0
    v_mov_b32 v67, 0
    v_mov_b32 v68, 0
    v_mov_b32 v69, 0
    v_mov_b32 v70, 0
    v_mov_b32 v71, 0
    v_mov_b32 v72, 0
    v_mov_b32 v73, 0
    v_mov_b32 v74, 0
    v_mov_b32 v75, 0
    v_mov_b32 v76, 0
    v_mov_b32 v77, 0
    v_mov_b32 v78, 0
    v_mov_b32 v79, 0
    v_add_u32 v17, 1, v19
    v_and_b32 v17, 3, v17
    v_add_u32 v20, 25, v19
    v_sub_u32 v20, v20, v17
    v_lshlrev_b32 v21, 3, v18
    v_sub_u32 v20, v20, v21
    v_lshlrev_b32 v20, 1, v20
    v_mul_u32_u24 v17, 4160, v17
    s_bfe_u32 s67, s60, 0x10001
    s_lshl_b32 s67, s67, 8
    s_mul_i32 s66, s101, 16640
    s_add_u32 s66, s66, s67
    s_add_u32 s66, s66, 57344
    v_add3_u32 v2, v20, v17, s66
    v_lshlrev_b32 v17, 5, v19
    v_lshl_add_u32 v17, v18, 4, v17
    s_mul_i32 s66, s101, 4608
    s_sub_u32 s66, s66, s67
    s_add_u32 s66, s66, 149536
    v_add_u32 v3, s66, v17
    v_mul_u32_u24 v16, 37, v1
    v_lshrrev_b32 v16, 8, v16
    v_mul_u32_u24 v17, 7, v16
    v_sub_u32 v17, v1, v17
    v_lshlrev_b32 v16, 2, v16
    v_add_u32 v16, s95, v16
    v_mul_u32_u24 v16, 896, v16
    v_lshl_add_u32 v16, v17, 4, v16
    s_mul_i32 s69, s62, 112
    s_mul_i32 s66, s101, 200704
    s_add_u32 s69, s69, s66
    v_add_u32 v241, s69, v16
    s_mul_i32 s56, s95, 12608
    s_mul_i32 s66, s101, 6272
    s_add_u32 s56, s56, s66
    s_add_u32 s56, s56, 90624
    s_and_b32 s98, s61, 3
    s_mul_i32 s98, s98, 1792
    s_lshl_b32 s66, s95, 3
    v_lshrrev_b32 v16, 3, v1
    v_add_u32 v16, s66, v16
    v_mul_u32_u24 v16, 1792, v16
    s_lshl_b32 s66, s48, 1
    s_add_u32 s66, s66, s101
    s_lshl_b32 s66, s66, 2
    s_add_u32 s66, s66, 6291456
    v_add_u32 v39, s66, v16
    v_and_b32 v48, 7, v1
    v_lshlrev_b32 v48, 2, v48
    v_add_u32 v49, 1, v48
    v_add_u32 v50, 2, v48
    v_add_u32 v51, 3, v48
    s_waitcnt vmcnt(0)
    s_mov_b32 s71, 0
L_xtv:
    buffer_load_dwordx4 v[40:43], v255, s[44:47], 0 offen sc1
    buffer_load_dword v38, v39, s[44:47], 0 offen sc1
    s_mov_b64 exec, -1
    s_waitcnt vmcnt(0)
L_xtv_chk:
    v_alignbit_b32 v44, v40, v40, v48
    v_alignbit_b32 v45, v41, v41, v49
    v_alignbit_b32 v46, v42, v42, v50
    v_alignbit_b32 v47, v43, v43, v51
    v_add3_u32 v44, v44, v45, v46
    v_add_u32 v44, v44, v47
    s_nop 1
    v_add_u32_dpp v44, v44, v44 quad_perm:[1,0,3,2] row_mask:0xf bank_mask:0xf
    s_nop 1
    v_add_u32_dpp v44, v44, v44 quad_perm:[2,3,0,1] row_mask:0xf bank_mask:0xf
    s_nop 1
    v_add_u32_dpp v44, v44, v44 row_half_mirror row_mask:0xf bank_mask:0xf
    v_add_u32 v44, s63, v44
    v_cmp_ne_u32 vcc, v44, v38
    s_add_u32 s71, s71, 1
    s_cbranch_vccz L_xtv_ok
    s_cmp_gt_u32 s71, 262144
    s_cbranch_scc1 L_xtv_ok
    s_mov_b64 exec, vcc
    s_sleep 2
    s_branch L_xtv
L_xtv_ok:
    ds_write_b128 v254, v[40:43]
    s_waitcnt lgkmcnt(0)
    s_barrier
L_conv:
    s_bitcmp1_b32 s60, 0
    s_cbranch_scc1 L_convB
    ds_read_b64 v[112:113], v2 offset:0
    ds_read_b64 v[114:115], v2 offset:8
    ds_read_b128 v[176:179], v3 offset:192
    ds_read_b64 v[116:117], v2 offset:512
    ds_read_b64 v[118:119], v2 offset:520
    ds_read_b128 v[180:183], v3 offset:704
    ds_read_b64 v[120:121], v2 offset:1024
    ds_read_b64 v[122:123], v2 offset:1032
    ds_read_b128 v[184:187], v3 offset:1216
    ds_read_b64 v[124:125], v2 offset:1536
    ds_read_b64 v[126:127], v2 offset:1544
    ds_read_b128 v[188:191], v3 offset:1728
    ds_read_b64 v[128:129], v2 offset:2048
    s_waitcnt lgkmcnt(10)
    v_mfma_f32_16x16x32_bf16 v[16:19], v[112:115], v[176:179], 0
    s_add_u32 m0, s57, 32256
    s_nop 0
    buffer_load_dwordx4 v243, s[24:27], 0 offen offset:512 lds
    ds_read_b64 v[130:131], v2 offset:2056
    ds_read_b128 v[192:195], v3 offset:2240
    ds_read_b64 v[132:133], v2 offset:2560
    s_waitcnt lgkmcnt(8)
    v_mfma_f32_16x16x32_bf16 v[20:23], v[120:123], v[180:183], 0
    ds_read_b64 v[134:135], v2 offset:2568
    ds_read_b128 v[196:199], v3 offset:2752
    ds_read_b64 v[136:137], v2 offset:3072
    ds_read_b64 v[138:139], v2 offset:3080
    ds_read_b128 v[200:203], v3 offset:3264
    s_waitcnt lgkmcnt(12)
    v_mfma_f32_16x16x32_bf16 v[20:23], v[116:119], v[184:187], v[20:23]
    ds_read_b64 v[140:141], v2 offset:3584
    v_mfma_f32_16x16x32_bf16 v[24:27], v[120:123], v[184:187], 0
    s_waitcnt lgkmcnt(11)
    v_mfma_f32_16x16x32_bf16 v[20:23], v[124:127], v[176:179], v[20:23]
    s_add_u32 m0, s57, 40320
    s_nop 0
    buffer_load_dwordx4 v243, s[24:27], 0 offen offset:640 lds
    ds_read_b64 v[142:143], v2 offset:3592
    ds_read_b128 v[204:207], v3 offset:3776
    v_mfma_f32_16x16x32_bf16 v[24:27], v[124:127], v[180:183], v[24:27]
    s_waitcnt lgkmcnt(12)
    v_mfma_f32_16x16x32_bf16 v[20:23], v[112:115], v[188:191], v[20:23]
    ds_read_b64 v[144:145], v2 offset:64
    v_mfma_f32_16x16x32_bf16 v[24:27], v[116:119], v[188:191], v[24:27]
    s_waitcnt lgkmcnt(11)
    v_mfma_f32_16x16x32_bf16 v[24:27], v[128:131], v[176:179], v[24:27]
    s_add_u32 m0, s57, 48384
    s_nop 0
    buffer_load_dwordx4 v243, s[24:27], 0 offen offset:768 lds
    ds_read_b64 v[146:147], v2 offset:72
    ds_read_b128 v[208:211], v3 offset:128
    v_mfma_f32_16x16x32_bf16 v[28:31], v[128:131], v[188:191], 0
    s_waitcnt lgkmcnt(12)
    v_mfma_f32_16x16x32_bf16 v[24:27], v[112:115], v[192:195], v[24:27]
    ds_read_b64 v[148:149], v2 offset:576
    v_mfma_f32_16x16x32_bf16 v[28:31], v[124:127], v[192:195], v[28:31]
    s_waitcnt lgkmcnt(11)
    v_mfma_f32_16x16x32_bf16 v[28:31], v[132:135], v[184:187], v[28:31]
    s_mov_b32 exec_hi, 0x00ffffff
    s_add_u32 m0, s56, s98
    s_lshl_b32 s71, s98, 5
    buffer_load_dwordx4 v241, s[28:31], s71 offen lds
    s_add_u32 s98, s98, 896
    s_cmp_eq_u32 s98, 6272
    s_cselect_b32 s98, 0, s98
    s_mov_b32 exec_hi, -1
    ds_read_b64 v[150:151], v2 offset:584
    ds_read_b128 v[212:215], v3 offset:640
    s_waitcnt lgkmcnt(12)
    v_mfma_f32_16x16x32_bf16 v[28:31], v[120:123], v[196:199], v[28:31]
    ds_read_b64 v[152:153], v2 offset:1088
    s_waitcnt lgkmcnt(11)
    v_mfma_f32_16x16x32_bf16 v[28:31], v[136:139], v[180:183], v[28:31]
    ds_read_b64 v[154:155], v2 offset:1096
    ds_read_b128 v[216:219], v3 offset:1152
    s_waitcnt lgkmcnt(12)
    v_mfma_f32_16x16x32_bf16 v[28:31], v[116:119], v[200:203], v[28:31]
    ds_read_b64 v[156:157], v2 offset:1600
    s_waitcnt lgkmcnt(11)
    v_mfma_f32_16x16x32_bf16 v[28:31], v[140:143], v[176:179], v[28:31]
    s_mov_b32 exec_hi, 0x00ffffff
    s_add_u32 m0, s56, s98
    s_lshl_b32 s71, s98, 5
    buffer_load_dwordx4 v241, s[28:31], s71 offen lds
    s_add_u32 s98, s98, 896
    s_cmp_eq_u32 s98, 6272
    s_cselect_b32 s98, 0, s98
    s_mov_b32 exec_hi, -1
    ds_read_b64 v[158:159], v2 offset:1608
    ds_read_b128 v[220:223], v3 offset:1664
    s_waitcnt lgkmcnt(12)
    v_mfma_f32_16x16x32_bf16 v[28:31], v[112:115], v[204:207], v[28:31]
    ds_read_b64 v[160:161], v2 offset:2112
    s_waitcnt lgkmcnt(10)
    v_mfma_f32_16x16x32_bf16 v[16:19], v[144:147], v[208:211], v[16:19]
    ds_read_b64 v[162:163], v2 offset:2120
    ds_read_b128 v[224:227], v3 offset:2176
    ds_read_b64 v[164:165], v2 offset:2624
    s_waitcnt lgkmcnt(8)
    v_mfma_f32_16x16x32_bf16 v[20:23], v[152:155], v[212:215], v[20:23]
    ds_read_b64 v[166:167], v2 offset:2632
    ds_read_b128 v[228:231], v3 offset:2688
    ds_read_b64 v[168:169], v2 offset:3136
    ds_read_b64 v[170:171], v2 offset:3144
    ds_read_b128 v[232:235], v3 offset:3200
    s_waitcnt lgkmcnt(12)
    v_mfma_f32_16x16x32_bf16 v[20:23], v[148:151], v[216:219], v[20:23]
    s_mov_b32 exec_hi, 0x00ffffff
    s_add_u32 m0, s56, s98
    s_lshl_b32 s71, s98, 5
    buffer_load_dwordx4 v241, s[28:31], s71 offen lds
    s_add_u32 s98, s98, 896
    s_cmp_eq_u32 s98, 6272
    s_cselect_b32 s98, 0, s98
    s_mov_b32 exec_hi, -1
    ds_read_b64 v[172:173], v2 offset:3648
    v_mfma_f32_16x16x32_bf16 v[24:27], v[152:155], v[216:219], v[24:27]
    s_waitcnt lgkmcnt(11)
    v_mfma_f32_16x16x32_bf16 v[20:23], v[156:159], v[208:211], v[20:23]
    ds_read_b64 v[174:175], v2 offset:3656
    ds_read_b128 v[236:239], v3 offset:3712
    v_mfma_f32_16x16x32_bf16 v[24:27], v[156:159], v[212:215], v[24:27]
    s_waitcnt lgkmcnt(12)
    v_mfma_f32_16x16x32_bf16 v[20:23], v[144:147], v[220:223], v[20:23]
    s_mov_b32 exec_hi, 0x00ffffff
    s_add_u32 m0, s56, s98
    s_lshl_b32 s71, s98, 5
    buffer_load_dwordx4 v241, s[28:31], s71 offen lds
    s_add_u32 s98, s98, 896
    s_cmp_eq_u32 s98, 6272
    s_cselect_b32 s98, 0, s98
    s_mov_b32 exec_hi, -1
    ds_read_b64 v[112:113], v2 offset:128
    v_mfma_f32_16x16x32_bf16 v[24:27], v[148:151], v[220:223], v[24:27]
    s_waitcnt lgkmcnt(11)
    v_mfma_f32_16x16x32_bf16 v[24:27], v[160:163], v[208:211], v[24:27]
    ds_read_b64 v[114:115], v2 offset:136
    ds_read_b128 v[176:179], v3 offset:64
    v_mfma_f32_16x16x32_bf16 v[28:31], v[160:163], v[220:223], v[28:31]
    s_waitcnt lgkmcnt(12)
    v_mfma_f32_16x16x32_bf16 v[24:27], v[144:147], v[224:227], v[24:27]
    s_mov_b32 exec_hi, 0x00ffffff
    s_add_u32 m0, s56, s98
    s_lshl_b32 s71, s98, 5
    buffer_load_dwordx4 v241, s[28:31], s71 offen lds
    s_add_u32 s98, s98, 896
    s_cmp_eq_u32 s98, 6272
    s_cselect_b32 s98, 0, s98
    s_mov_b32 exec_hi, -1
    ds_read_b64 v[116:117], v2 offset:640
    v_mfma_f32_16x16x32_bf16 v[28:31], v[156:159], v[224:227], v[28:31]
    s_waitcnt lgkmcnt(11)
    v_mfma_f32_16x16x32_bf16 v[28:31], v[164:167], v[216:219], v[28:31]
    ds_read_b64 v[118:119], v2 offset:648
    ds_read_b128 v[180:183], v3 offset:576
    s_waitcnt lgkmcnt(12)
    v_mfma_f32_16x16x32_bf16 v[28:31], v[152:155], v[228:231], v[28:31]
    ds_read_b64 v[120:121], v2 offset:1152
    s_waitcnt lgkmcnt(11)
    v_mfma_f32_16x16x32_bf16 v[28:31], v[168:171], v[212:215], v[28:31]
    s_mov_b32 exec_hi, 0x00ffffff
    s_add_u32 m0, s56, s98
    s_lshl_b32 s71, s98, 5
    buffer_load_dwordx4 v241, s[28:31], s71 offen lds
    s_add_u32 s98, s98, 896
    s_cmp_eq_u32 s98, 6272
    s_cselect_b32 s98, 0, s98
    s_mov_b32 exec_hi, -1
    ds_read_b64 v[122:123], v2 offset:1160
    ds_read_b128 v[184:187], v3 offset:1088
    s_waitcnt lgkmcnt(12)
    v_mfma_f32_16x16x32_bf16 v[28:31], v[148:151], v[232:235], v[28:31]
    ds_read_b64 v[124:125], v2 offset:1664
    s_waitcnt lgkmcnt(11)
    v_mfma_f32_16x16x32_bf16 v[28:31], v[172:175], v[208:211], v[28:31]
    ds_read_b64 v[126:127], v2 offset:1672
    ds_read_b128 v[188:191], v3 offset:1600
    s_waitcnt lgkmcnt(12)
    v_mfma_f32_16x16x32_bf16 v[28:31], v[144:147], v[236:239], v[28:31]
    ds_read_b64 v[128:129], v2 offset:2176
    s_waitcnt lgkmcnt(10)
    v_mfma_f32_16x16x32_bf16 v[16:19], v[112:115], v[176:179], v[16:19]
    s_mov_b32 exec_hi, 0x00ffffff
    s_add_u32 m0, s56, s98
    s_lshl_b32 s71, s98, 5
    buffer_load_dwordx4 v241, s[28:31], s71 offen lds
    s_add_u32 s98, s98, 896
    s_cmp_eq_u32 s98, 6272
    s_cselect_b32 s98, 0, s98
    s_mov_b32 exec_hi, -1
    ds_read_b64 v[130:131], v2 offset:2184
    ds_read_b128 v[192:195], v3 offset:2112
    ds_read_b64 v[132:133], v2 offset:2688
    s_waitcnt lgkmcnt(8)
    v_mfma_f32_16x16x32_bf16 v[20:23], v[120:123], v[180:183], v[20:23]
    ds_read_b64 v[134:135], v2 offset:2696
    ds_read_b128 v[196:199], v3 offset:2624
    ds_read_b64 v[136:137], v2 offset:3200
    ds_read_b64 v[138:139], v2 offset:3208
    ds_read_b128 v[200:203], v3 offset:3136
    s_waitcnt lgkmcnt(12)
    v_mfma_f32_16x16x32_bf16 v[20:23], v[116:119], v[184:187], v[20:23]
    ds_read_b64 v[140:141], v2 offset:3712
    v_mfma_f32_16x16x32_bf16 v[24:27], v[120:123], v[184:187], v[24:27]
    s_waitcnt lgkmcnt(11)
    v_mfma_f32_16x16x32_bf16 v[20:23], v[124:127], v[176:179], v[20:23]
    ds_read_b64 v[142:143], v2 offset:3720
    ds_read_b128 v[204:207], v3 offset:3648
    v_mfma_f32_16x16x32_bf16 v[24:27], v[124:127], v[180:183], v[24:27]
    s_waitcnt lgkmcnt(12)
    v_mfma_f32_16x16x32_bf16 v[20:23], v[112:115], v[188:191], v[20:23]
    ds_read_b64 v[144:145], v2 offset:192
    v_mfma_f32_16x16x32_bf16 v[24:27], v[116:119], v[188:191], v[24:27]
    s_waitcnt lgkmcnt(11)
    v_mfma_f32_16x16x32_bf16 v[24:27], v[128:131], v[176:179], v[24:27]
    ds_read_b64 v[146:147], v2 offset:200
    ds_read_b128 v[208:211], v3 offset:0
    v_mfma_f32_16x16x32_bf16 v[28:31], v[128:131], v[188:191], v[28:31]
    s_waitcnt lgkmcnt(12)
    v_mfma_f32_16x16x32_bf16 v[24:27], v[112:115], v[192:195], v[24:27]
    ds_read_b64 v[148:149], v2 offset:704
    v_mfma_f32_16x16x32_bf16 v[28:31], v[124:127], v[192:195], v[28:31]
    s_waitcnt lgkmcnt(11)
    v_mfma_f32_16x16x32_bf16 v[28:31], v[132:135], v[184:187], v[28:31]
    ds_read_b64 v[150:151], v2 offset:712
    ds_read_b128 v[212:215], v3 offset:512
    s_waitcnt lgkmcnt(12)
    v_mfma_f32_16x16x32_bf16 v[28:31], v[120:123], v[196:199], v[28:31]
    ds_read_b64 v[152:153], v2 offset:1216
    s_waitcnt lgkmcnt(11)
    v_mfma_f32_16x16x32_bf16 v[28:31], v[136:139], v[180:183], v[28:31]
    ds_read_b64 v[36:37], v240
    ds_read_b64 v[38:39], v240 offset:1536
    s_waitcnt lgkmcnt(12)
    v_mfma_f32_16x16x32_bf16 v[28:31], v[116:119], v[200:203], v[28:31]
    ds_read_b64 v[154:155], v2 offset:1224
    s_waitcnt lgkmcnt(11)
    v_mfma_f32_16x16x32_bf16 v[28:31], v[140:143], v[176:179], v[28:31]
    ds_read_b128 v[216:219], v3 offset:1024
    ds_read_b64 v[156:157], v2 offset:1728
    s_waitcnt lgkmcnt(12)
    v_mfma_f32_16x16x32_bf16 v[28:31], v[112:115], v[204:207], v[28:31]
    ds_read_b64 v[158:159], v2 offset:1736
    s_waitcnt lgkmcnt(10)
    v_mfma_f32_16x16x32_bf16 v[16:19], v[144:147], v[208:211], v[16:19]
    buffer_load_dwordx3 v[244:246], v242, s[44:47], 0 offen sc1
    ds_read_b128 v[220:223], v3 offset:1536
    ds_read_b64 v[160:161], v2 offset:2240
    ds_read_b64 v[162:163], v2 offset:2248
    s_waitcnt lgkmcnt(6)
    v_mfma_f32_16x16x32_bf16 v[20:23], v[152:155], v[212:215], v[20:23]
    ds_read_b128 v[224:227], v3 offset:2048
    ds_read_b64 v[164:165], v2 offset:2752
    ds_read_b64 v[166:167], v2 offset:2760
    ds_read_b128 v[228:231], v3 offset:2560
    ds_read_b64 v[168:169], v2 offset:3264
    ds_read_b64 v[170:171], v2 offset:3272
    ds_read_b128 v[232:235], v3 offset:3072
    s_waitcnt lgkmcnt(12)
    v_mfma_f32_16x16x32_bf16 v[20:23], v[148:151], v[216:219], v[20:23]
    ds_read_b64 v[172:173], v2 offset:3776
    v_mfma_f32_16x16x32_bf16 v[24:27], v[152:155], v[216:219], v[24:27]
    s_waitcnt lgkmcnt(11)
    v_mfma_f32_16x16x32_bf16 v[20:23], v[156:159], v[208:211], v[20:23]
    ds_read_b64 v[174:175], v2 offset:3784
    ds_read_b128 v[236:239], v3 offset:3584
    v_mfma_f32_16x16x32_bf16 v[24:27], v[156:159], v[212:215], v[24:27]
    s_waitcnt lgkmcnt(12)
    v_mfma_f32_16x16x32_bf16 v[20:23], v[144:147], v[220:223], v[20:23]
    v_mfma_f32_16x16x32_bf16 v[24:27], v[148:151], v[220:223], v[24:27]
    s_waitcnt lgkmcnt(10)
    v_mfma_f32_16x16x32_bf16 v[24:27], v[160:163], v[208:211], v[24:27]
    v_mfma_f32_16x16x32_bf16 v[28:31], v[160:163], v[220:223], v[28:31]
    s_waitcnt lgkmcnt(9)
    v_mfma_f32_16x16x32_bf16 v[24:27], v[144:147], v[224:227], v[24:27]
    v_mfma_f32_16x16x32_bf16 v[28:31], v[156:159], v[224:227], v[28:31]
    s_waitcnt lgkmcnt(7)
    v_mfma_f32_16x16x32_bf16 v[28:31], v[164:167], v[216:219], v[28:31]
    s_waitcnt lgkmcnt(6)
    v_mfma_f32_16x16x32_bf16 v[28:31], v[152:155], v[228:231], v[28:31]
    s_waitcnt lgkmcnt(4)
    v_mfma_f32_16x16x32_bf16 v[28:31], v[168:171], v[212:215], v[28:31]
    s_mov_b32 s71, 0
    s_waitcnt vmcnt(0)
    s_branch L_pfb1_chk
L_pfb1:
    buffer_load_dwordx3 v[244:246], v242, s[44:47], 0 offen sc1
    s_waitcnt vmcnt(0)
L_pfb1_chk:
    v_cmp_ne_u32 vcc, s63, v244
    s_add_u32 s71, s71, 1
    s_cbranch_vccz L_pfb1_ok
    s_cmp_gt_u32 s71, 262144
    s_cbranch_scc1 L_pfb1_ok
    s_mov_b64 exec, vcc
    s_sleep 4
    s_branch L_pfb1
L_pfb1_ok:
    s_mov_b64 exec, -1
    s_cmp_eq_u32 s101, 0
    s_cselect_b64 vcc, -1, 0
    s_lshl_b32 s66, s101, 2
    s_add_u32 s66, s66, 158468
    v_cndmask_b32 v33, v246, v245, vcc
    v_mov_b32 v34, s66
    s_nop 1
    v_max_u32_dpp v33, v33, v33 quad_perm:[1,0,3,2] row_mask:0xf bank_mask:0xf
    s_nop 1
    v_max_u32_dpp v33, v33, v33 quad_perm:[2,3,0,1] row_mask:0xf bank_mask:0xf
    s_nop 1
    v_max_u32_dpp v33, v33, v33 row_half_mirror row_mask:0xf bank_mask:0xf
    s_nop 1
    v_max_u32_dpp v33, v33, v33 row_mirror row_mask:0xf bank_mask:0xf
    v_mov_b32 v32, v33
    s_nop 1
    v_permlane16_swap_b32 v33, v32
    v_max_u32 v33, v33, v32
    v_mov_b32 v32, v33
    s_nop 1
    v_permlane32_swap_b32 v33, v32
    v_max_u32 v33, v33, v32
    s_mov_b64 exec, 1
    ds_max_u32 v34, v33
    s_mov_b64 exec, -1
    s_waitcnt lgkmcnt(4)
    v_mfma_f32_16x16x32_bf16 v[28:31], v[148:151], v[232:235], v[28:31]
    s_waitcnt lgkmcnt(2)
    v_mfma_f32_16x16x32_bf16 v[28:31], v[172:175], v[208:211], v[28:31]
    s_waitcnt lgkmcnt(1)
    v_mfma_f32_16x16x32_bf16 v[28:31], v[144:147], v[236:239], v[28:31]
    s_branch L_convred
L_convB:
    ds_read_b64 v[112:113], v2 offset:0
    ds_read_b64 v[114:115], v2 offset:8
    ds_read_b128 v[176:179], v3 offset:192
    ds_read_b64 v[116:117], v2 offset:512
    ds_read_b64 v[118:119], v2 offset:520
    ds_read_b128 v[180:183], v3 offset:704
    ds_read_b64 v[120:121], v2 offset:1024
    ds_read_b64 v[122:123], v2 offset:1032
    ds_read_b128 v[184:187], v3 offset:1216
    ds_read_b64 v[124:125], v2 offset:1536
    ds_read_b64 v[126:127], v2 offset:1544
    ds_read_b128 v[188:191], v3 offset:1728
    ds_read_b64 v[128:129], v2 offset:2048
    s_waitcnt lgkmcnt(8)
    v_mfma_f32_16x16x32_bf16 v[16:19], v[116:119], v[176:179], 0
    s_add_u32 m0, s57, 32256
    s_nop 0
    buffer_load_dwordx4 v243, s[24:27], 0 offen offset:512 lds
    ds_read_b64 v[130:131], v2 offset:2056
    ds_read_b128 v[192:195], v3 offset:2240
    ds_read_b64 v[132:133], v2 offset:2560
    ds_read_b64 v[134:135], v2 offset:2568
    ds_read_b128 v[196:199], v3 offset:2752
    s_waitcnt lgkmcnt(12)
    v_mfma_f32_16x16x32_bf16 v[16:19], v[112:115], v[180:183], v[16:19]
    ds_read_b64 v[136:137], v2 offset:3072
    v_mfma_f32_16x16x32_bf16 v[20:23], v[116:119], v[180:183], 0
    s_waitcnt lgkmcnt(11)
    v_mfma_f32_16x16x32_bf16 v[20:23], v[120:123], v[176:179], v[20:23]
    ds_read_b64 v[138:139], v2 offset:3080
    ds_read_b128 v[200:203], v3 offset:3264
    s_waitcnt lgkmcnt(12)
    v_mfma_f32_16x16x32_bf16 v[20:23], v[112:115], v[184:187], v[20:23]
    s_add_u32 m0, s57, 40320
    s_nop 0
    buffer_load_dwordx4 v243, s[24:27], 0 offen offset:640 lds
    ds_read_b64 v[144:145], v2 offset:64
    s_waitcnt lgkmcnt(11)
    v_mfma_f32_16x16x32_bf16 v[24:27], v[124:127], v[184:187], 0
    ds_read_b64 v[146:147], v2 offset:72
    ds_read_b128 v[208:211], v3 offset:128
    s_waitcnt lgkmcnt(12)
    v_mfma_f32_16x16x32_bf16 v[24:27], v[120:123], v[188:191], v[24:27]
    ds_read_b64 v[148:149], v2 offset:576
    v_mfma_f32_16x16x32_bf16 v[28:31], v[124:127], v[188:191], 0
    s_waitcnt lgkmcnt(11)
    v_mfma_f32_16x16x32_bf16 v[24:27], v[128:131], v[180:183], v[24:27]
    s_add_u32 m0, s57, 48384
    s_nop 0
    buffer_load_dwordx4 v243, s[24:27], 0 offen offset:768 lds
    ds_read_b64 v[150:151], v2 offset:584
    ds_read_b128 v[212:215], v3 offset:640
    v_mfma_f32_16x16x32_bf16 v[28:31], v[128:131], v[184:187], v[28:31]
    s_waitcnt lgkmcnt(12)
    v_mfma_f32_16x16x32_bf16 v[24:27], v[116:119], v[192:195], v[24:27]
    ds_read_b64 v[152:153], v2 offset:1088
    v_mfma_f32_16x16x32_bf16 v[28:31], v[120:123], v[192:195], v[28:31]
    s_waitcnt lgkmcnt(11)
    v_mfma_f32_16x16x32_bf16 v[24:27], v[132:135], v[176:179], v[24:27]
    s_mov_b32 exec_hi, 0x00ffffff
    s_add_u32 m0, s56, s98
    s_lshl_b32 s71, s98, 5
    buffer_load_dwordx4 v241, s[28:31], s71 offen lds
    s_add_u32 s98, s98, 896
    s_cmp_eq_u32 s98, 6272
    s_cselect_b32 s98, 0, s98
    s_mov_b32 exec_hi, -1
    ds_read_b64 v[154:155], v2 offset:1096
    ds_read_b128 v[216:219], v3 offset:1152
    v_mfma_f32_16x16x32_bf16 v[28:31], v[132:135], v[180:183], v[28:31]
    s_waitcnt lgkmcnt(12)
    v_mfma_f32_16x16x32_bf16 v[24:27], v[112:115], v[196:199], v[24:27]
    ds_read_b64 v[156:157], v2 offset:1600
    v_mfma_f32_16x16x32_bf16 v[28:31], v[116:119], v[196:199], v[28:31]
    s_waitcnt lgkmcnt(11)
    v_mfma_f32_16x16x32_bf16 v[28:31], v[136:139], v[176:179], v[28:31]
    s_mov_b32 exec_hi, 0x00ffffff
    s_add_u32 m0, s56, s98
    s_lshl_b32 s71, s98, 5
    buffer_load_dwordx4 v241, s[28:31], s71 offen lds
    s_add_u32 s98, s98, 896
    s_cmp_eq_u32 s98, 6272
    s_cselect_b32 s98, 0, s98
    s_mov_b32 exec_hi, -1
    ds_read_b64 v[158:159], v2 offset:1608
    ds_read_b128 v[220:223], v3 offset:1664
    s_waitcnt lgkmcnt(12)
    v_mfma_f32_16x16x32_bf16 v[28:31], v[112:115], v[200:203], v[28:31]
    ds_read_b64 v[160:161], v2 offset:2112
    s_waitcnt lgkmcnt(8)
    v_mfma_f32_16x16x32_bf16 v[16:19], v[148:151], v[208:211], v[16:19]
    ds_read_b64 v[162:163], v2 offset:2120
    ds_read_b128 v[224:227], v3 offset:2176
    ds_read_b64 v[164:165], v2 offset:2624
    ds_read_b64 v[166:167], v2 offset:2632
    ds_read_b128 v[228:231], v3 offset:2688
    s_waitcnt lgkmcnt(12)
    v_mfma_f32_16x16x32_bf16 v[16:19], v[144:147], v[212:215], v[16:19]
    ds_read_b64 v[168:169], v2 offset:3136
    v_mfma_f32_16x16x32_bf16 v[20:23], v[148:151], v[212:215], v[20:23]
    s_mov_b32 exec_hi, 0x00ffffff
    s_add_u32 m0, s56, s98
    s_lshl_b32 s71, s98, 5
    buffer_load_dwordx4 v241, s[28:31], s71 offen lds
    s_add_u32 s98, s98, 896
    s_cmp_eq_u32 s98, 6272
    s_cselect_b32 s98, 0, s98
    s_mov_b32 exec_hi, -1
    s_waitcnt lgkmcnt(11)
    v_mfma_f32_16x16x32_bf16 v[20:23], v[152:155], v[208:211], v[20:23]
    ds_read_b64 v[170:171], v2 offset:3144
    ds_read_b128 v[232:235], v3 offset:3200
    s_waitcnt lgkmcnt(12)
    v_mfma_f32_16x16x32_bf16 v[20:23], v[144:147], v[216:219], v[20:23]
    ds_read_b64 v[112:113], v2 offset:128
    s_waitcnt lgkmcnt(11)
    v_mfma_f32_16x16x32_bf16 v[24:27], v[156:159], v[216:219], v[24:27]
    ds_read_b64 v[114:115], v2 offset:136
    ds_read_b128 v[176:179], v3 offset:64
    s_waitcnt lgkmcnt(12)
    v_mfma_f32_16x16x32_bf16 v[24:27], v[152:155], v[220:223], v[24:27]
    s_mov_b32 exec_hi, 0x00ffffff
    s_add_u32 m0, s56, s98
    s_lshl_b32 s71, s98, 5
    buffer_load_dwordx4 v241, s[28:31], s71 offen lds
    s_add_u32 s98, s98, 896
    s_cmp_eq_u32 s98, 6272
    s_cselect_b32 s98, 0, s98
    s_mov_b32 exec_hi, -1
    ds_read_b64 v[116:117], v2 offset:640
    v_mfma_f32_16x16x32_bf16 v[28:31], v[156:159], v[220:223], v[28:31]
    s_waitcnt lgkmcnt(11)
    v_mfma_f32_16x16x32_bf16 v[24:27], v[160:163], v[212:215], v[24:27]
    ds_read_b64 v[118:119], v2 offset:648
    ds_read_b128 v[180:183], v3 offset:576
    v_mfma_f32_16x16x32_bf16 v[28:31], v[160:163], v[216:219], v[28:31]
    s_waitcnt lgkmcnt(12)
    v_mfma_f32_16x16x32_bf16 v[24:27], v[148:151], v[224:227], v[24:27]
    s_mov_b32 exec_hi, 0x00ffffff
    s_add_u32 m0, s56, s98
    s_lshl_b32 s71, s98, 5
    buffer_load_dwordx4 v241, s[28:31], s71 offen lds
    s_add_u32 s98, s98, 896
    s_cmp_eq_u32 s98, 6272
    s_cselect_b32 s98, 0, s98
    s_mov_b32 exec_hi, -1
    ds_read_b64 v[120:121], v2 offset:1152
    v_mfma_f32_16x16x32_bf16 v[28:31], v[152:155], v[224:227], v[28:31]
    s_waitcnt lgkmcnt(11)
    v_mfma_f32_16x16x32_bf16 v[24:27], v[164:167], v[208:211], v[24:27]
    ds_read_b64 v[122:123], v2 offset:1160
    ds_read_b128 v[184:187], v3 offset:1088
    v_mfma_f32_16x16x32_bf16 v[28:31], v[164:167], v[212:215], v[28:31]
    s_waitcnt lgkmcnt(12)
    v_mfma_f32_16x16x32_bf16 v[24:27], v[144:147], v[228:231], v[24:27]
    s_mov_b32 exec_hi, 0x00ffffff
    s_add_u32 m0, s56, s98
    s_lshl_b32 s71, s98, 5
    buffer_load_dwordx4 v241, s[28:31], s71 offen lds
    s_add_u32 s98, s98, 896
    s_cmp_eq_u32 s98, 6272
    s_cselect_b32 s98, 0, s98
    s_mov_b32 exec_hi, -1
    ds_read_b64 v[124:125], v2 offset:1664
    v_mfma_f32_16x16x32_bf16 v[28:31], v[148:151], v[228:231], v[28:31]
    s_waitcnt lgkmcnt(11)
    v_mfma_f32_16x16x32_bf16 v[28:31], v[168:171], v[208:211], v[28:31]
    ds_read_b64 v[126:127], v2 offset:1672
    ds_read_b128 v[188:191], v3 offset:1600
    s_waitcnt lgkmcnt(12)
    v_mfma_f32_16x16x32_bf16 v[28:31], v[144:147], v[232:235], v[28:31]
    ds_read_b64 v[128:129], v2 offset:2176
    s_waitcnt lgkmcnt(8)
    v_mfma_f32_16x16x32_bf16 v[16:19], v[116:119], v[176:179], v[16:19]
    s_mov_b32 exec_hi, 0x00ffffff
    s_add_u32 m0, s56, s98
    s_lshl_b32 s71, s98, 5
    buffer_load_dwordx4 v241, s[28:31], s71 offen lds
    s_add_u32 s98, s98, 896
    s_cmp_eq_u32 s98, 6272
    s_cselect_b32 s98, 0, s98
    s_mov_b32 exec_hi, -1
    ds_read_b64 v[130:131], v2 offset:2184
    ds_read_b128 v[192:195], v3 offset:2112
    ds_read_b64 v[132:133], v2 offset:2688
    ds_read_b64 v[134:135], v2 offset:2696
    ds_read_b128 v[196:199], v3 offset:2624
    s_waitcnt lgkmcnt(12)
    v_mfma_f32_16x16x32_bf16 v[16:19], v[112:115], v[180:183], v[16:19]
    ds_read_b64 v[136:137], v2 offset:3200
    v_mfma_f32_16x16x32_bf16 v[20:23], v[116:119], v[180:183], v[20:23]
    s_waitcnt lgkmcnt(11)
    v_mfma_f32_16x16x32_bf16 v[20:23], v[120:123], v[176:179], v[20:23]
    ds_read_b64 v[138:139], v2 offset:3208
    ds_read_b128 v[200:203], v3 offset:3136
    s_waitcnt lgkmcnt(12)
    v_mfma_f32_16x16x32_bf16 v[20:23], v[112:115], v[184:187], v[20:23]
    ds_read_b64 v[144:145], v2 offset:192
    s_waitcnt lgkmcnt(11)
    v_mfma_f32_16x16x32_bf16 v[24:27], v[124:127], v[184:187], v[24:27]
    ds_read_b64 v[146:147], v2 offset:200
    ds_read_b128 v[208:211], v3 offset:0
    s_waitcnt lgkmcnt(12)
    v_mfma_f32_16x16x32_bf16 v[24:27], v[120:123], v[188:191], v[24:27]
    ds_read_b64 v[148:149], v2 offset:704
    v_mfma_f32_16x16x32_bf16 v[28:31], v[124:127], v[188:191], v[28:31]
    s_waitcnt lgkmcnt(11)
    v_mfma_f32_16x16x32_bf16 v[24:27], v[128:131], v[180:183], v[24:27]
    ds_read_b64 v[150:151], v2 offset:712
    ds_read_b128 v[212:215], v3 offset:512
    v_mfma_f32_16x16x32_bf16 v[28:31], v[128:131], v[184:187], v[28:31]
    s_waitcnt lgkmcnt(12)
    v_mfma_f32_16x16x32_bf16 v[24:27], v[116:119], v[192:195], v[24:27]
    ds_read_b64 v[152:153], v2 offset:1216
    v_mfma_f32_16x16x32_bf16 v[28:31], v[120:123], v[192:195], v[28:31]
    s_waitcnt lgkmcnt(11)
    v_mfma_f32_16x16x32_bf16 v[24:27], v[132:135], v[176:179], v[24:27]
    ds_read_b64 v[154:155], v2 offset:1224
    ds_read_b128 v[216:219], v3 offset:1024
    v_mfma_f32_16x16x32_bf16 v[28:31], v[132:135], v[180:183], v[28:31]
    s_waitcnt lgkmcnt(12)
    v_mfma_f32_16x16x32_bf16 v[24:27], v[112:115], v[196:199], v[24:27]
    ds_read_b64 v[36:37], v240
    ds_read_b64 v[38:39], v240 offset:512
    v_mfma_f32_16x16x32_bf16 v[28:31], v[116:119], v[196:199], v[28:31]
    s_waitcnt lgkmcnt(12)
    v_mfma_f32_16x16x32_bf16 v[28:31], v[136:139], v[176:179], v[28:31]
    ds_read_b64 v[156:157], v2 offset:1728
    s_waitcnt lgkmcnt(12)
    v_mfma_f32_16x16x32_bf16 v[28:31], v[112:115], v[200:203], v[28:31]
    ds_read_b64 v[158:159], v2 offset:1736
    s_waitcnt lgkmcnt(8)
    v_mfma_f32_16x16x32_bf16 v[16:19], v[148:151], v[208:211], v[16:19]
    buffer_load_dwordx3 v[244:246], v242, s[44:47], 0 offen sc1
    ds_read_b128 v[220:223], v3 offset:1536
    ds_read_b64 v[160:161], v2 offset:2240
    ds_read_b64 v[162:163], v2 offset:2248
    ds_read_b128 v[224:227], v3 offset:2048
    ds_read_b64 v[164:165], v2 offset:2752
    s_waitcnt lgkmcnt(12)
    v_mfma_f32_16x16x32_bf16 v[16:19], v[144:147], v[212:215], v[16:19]
    ds_read_b64 v[166:167], v2 offset:2760
    v_mfma_f32_16x16x32_bf16 v[20:23], v[148:151], v[212:215], v[20:23]
    s_waitcnt lgkmcnt(11)
    v_mfma_f32_16x16x32_bf16 v[20:23], v[152:155], v[208:211], v[20:23]
    ds_read_b128 v[228:231], v3 offset:2560
    ds_read_b64 v[168:169], v2 offset:3264
    s_waitcnt lgkmcnt(12)
    v_mfma_f32_16x16x32_bf16 v[20:23], v[144:147], v[216:219], v[20:23]
    ds_read_b64 v[170:171], v2 offset:3272
    s_waitcnt lgkmcnt(9)
    v_mfma_f32_16x16x32_bf16 v[24:27], v[156:159], v[216:219], v[24:27]
    ds_read_b128 v[232:235], v3 offset:3072
    s_waitcnt lgkmcnt(9)
    v_mfma_f32_16x16x32_bf16 v[24:27], v[152:155], v[220:223], v[24:27]
    v_mfma_f32_16x16x32_bf16 v[28:31], v[156:159], v[220:223], v[28:31]
    s_waitcnt lgkmcnt(7)
    v_mfma_f32_16x16x32_bf16 v[24:27], v[160:163], v[212:215], v[24:27]
    v_mfma_f32_16x16x32_bf16 v[28:31], v[160:163], v[216:219], v[28:31]
    s_waitcnt lgkmcnt(6)
    v_mfma_f32_16x16x32_bf16 v[24:27], v[148:151], v[224:227], v[24:27]
    v_mfma_f32_16x16x32_bf16 v[28:31], v[152:155], v[224:227], v[28:31]
    s_waitcnt lgkmcnt(4)
    v_mfma_f32_16x16x32_bf16 v[24:27], v[164:167], v[208:211], v[24:27]
    v_mfma_f32_16x16x32_bf16 v[28:31], v[164:167], v[212:215], v[28:31]
    s_waitcnt lgkmcnt(3)
    v_mfma_f32_16x16x32_bf16 v[24:27], v[144:147], v[228:231], v[24:27]
    s_mov_b32 s71, 0
    s_waitcnt vmcnt(0)
    s_branch L_pfb2_chk
L_pfb2:
    buffer_load_dwordx3 v[244:246], v242, s[44:47], 0 offen sc1
    s_waitcnt vmcnt(0)
L_pfb2_chk:
    v_cmp_ne_u32 vcc, s63, v244
    s_add_u32 s71, s71, 1
    s_cbranch_vccz L_pfb2_ok
    s_cmp_gt_u32 s71, 262144
    s_cbranch_scc1 L_pfb2_ok
    s_mov_b64 exec, vcc
    s_sleep 4
    s_branch L_pfb2
L_pfb2_ok:
    s_mov_b64 exec, -1
    s_cmp_eq_u32 s101, 0
    s_cselect_b64 vcc, -1, 0
    s_lshl_b32 s66, s101, 2
    s_add_u32 s66, s66, 158468
    v_cndmask_b32 v33, v246, v245, vcc
    v_mov_b32 v34, s66
    s_nop 1
    v_max_u32_dpp v33, v33, v33 quad_perm:[1,0,3,2] row_mask:0xf bank_mask:0xf
    s_nop 1
    v_max_u32_dpp v33, v33, v33 quad_perm:[2,3,0,1] row_mask:0xf bank_mask:0xf
    s_nop 1
    v_max_u32_dpp v33, v33, v33 row_half_mirror row_mask:0xf bank_mask:0xf
    s_nop 1
    v_max_u32_dpp v33, v33, v33 row_mirror row_mask:0xf bank_mask:0xf
    v_mov_b32 v32, v33
    s_nop 1
    v_permlane16_swap_b32 v33, v32
    v_max_u32 v33, v33, v32
    v_mov_b32 v32, v33
    s_nop 1
    v_permlane32_swap_b32 v33, v32
    v_max_u32 v33, v33, v32
    s_mov_b64 exec, 1
    ds_max_u32 v34, v33
    s_mov_b64 exec, -1
    v_mfma_f32_16x16x32_bf16 v[28:31], v[148:151], v[228:231], v[28:31]
    s_waitcnt lgkmcnt(2)
    v_mfma_f32_16x16x32_bf16 v[28:31], v[168:171], v[208:211], v[28:31]
    s_waitcnt lgkmcnt(1)
    v_mfma_f32_16x16x32_bf16 v[28:31], v[144:147], v[232:235], v[28:31]
L_convred:
    s_waitcnt lgkmcnt(0)
    v_and_b32 v48, 0xffff0000, v37
    v_lshlrev_b32 v49, 16, v37
    v_and_b32 v50, 0xffff0000, v36
    v_lshlrev_b32 v51, 16, v36
    v_and_b32 v52, 0xffff0000, v39
    v_lshlrev_b32 v53, 16, v39
    v_and_b32 v54, 0xffff0000, v38
    v_lshlrev_b32 v55, 16, v38
    s_bitcmp1_b32 s60, 1
    s_cbranch_scc0 L_cr0
    v_pk_fma_f32 v[164:165], s[64:65], v[48:49], v[24:25] op_sel_hi:[0,1,1]
    v_pk_fma_f32 v[166:167], s[64:65], v[50:51], v[26:27] op_sel_hi:[0,1,1]
    v_pk_fma_f32 v[168:169], s[64:65], v[52:53], v[28:29] op_sel_hi:[0,1,1]
    v_pk_fma_f32 v[170:171], s[64:65], v[54:55], v[30:31] op_sel_hi:[0,1,1]
    v_mov_b32 v172, v16
    v_mov_b32 v173, v17
    v_mov_b32 v174, v18
    v_mov_b32 v175, v19
    v_mov_b32 v176, v20
    v_mov_b32 v177, v21
    v_mov_b32 v178, v22
    v_mov_b32 v179, v23
    s_branch L_cr1
L_cr0:
    v_pk_fma_f32 v[164:165], s[64:65], v[48:49], v[16:17] op_sel_hi:[0,1,1]
    v_pk_fma_f32 v[166:167], s[64:65], v[50:51], v[18:19] op_sel_hi:[0,1,1]
    v_pk_fma_f32 v[168:169], s[64:65], v[52:53], v[20:21] op_sel_hi:[0,1,1]
    v_pk_fma_f32 v[170:171], s[64:65], v[54:55], v[22:23] op_sel_hi:[0,1,1]
    v_mov_b32 v172, v24
    v_mov_b32 v173, v25
    v_mov_b32 v174, v26
    v_mov_b32 v175, v27
    v_mov_b32 v176, v28
    v_mov_b32 v177, v29
    v_mov_b32 v178, v30
    v_mov_b32 v179, v31
L_cr1:
    v_mov_b32 v30, 1
    v_mov_b32 v31, 158464
    s_cmp_ge_u32 s60, 4
    s_cbranch_scc1 L_vy
    ds_write_b128 v104, v[172:175]
    ds_write_b128 v104, v[176:179] offset:1024
    s_waitcnt lgkmcnt(0)
    s_mov_b64 exec, 1
    ds_add_u32 v31, v30 offset:16
    s_mov_b64 exec, -1
L_ms6:
    ds_read_b32 v32, v31 offset:16
    s_waitcnt lgkmcnt(0)
    v_cmp_gt_u32 vcc, 4, v32
    s_cbranch_vccnz L_ms6
    ds_read_b128 v[172:175], v105
    ds_read_b128 v[176:179], v105 offset:1024
    buffer_load_dwordx4 v[240:243], v250, s[44:47], 0 offen offset:0 sc1
    buffer_load_dwordx4 v[244:247], v250, s[44:47], 0 offen offset:1024 sc1
    s_mov_b32 m0, s100
    s_nop 0
    buffer_load_dwordx4 v97, s[44:47], 0 offen sc1 lds
    buffer_load_dwordx4 v97, s[44:47], 0 offen offset:1024 sc1 lds
    s_add_u32 m0, s100, 8192
    s_sub_u32 s100, s3, s100
    buffer_load_dwordx4 v99, s[44:47], 0 offen sc1 lds
    buffer_load_dwordx4 v99, s[44:47], 0 offen offset:1024 sc1 lds
    s_waitcnt lgkmcnt(0)
    v_pk_add_f32 v[164:165], v[164:165], v[172:173]
    v_pk_add_f32 v[166:167], v[166:167], v[174:175]
    v_pk_add_f32 v[168:169], v[168:169], v[176:177]
    v_pk_add_f32 v[170:171], v[170:171], v[178:179]
    v_cvt_pk_bf16_f32 v172, v164, v165
    v_cvt_pk_bf16_f32 v173, v166, v167
    v_cvt_pk_bf16_f32 v174, v168, v169
    v_cvt_pk_bf16_f32 v175, v170, v171
    ds_write_b64 v106, v[172:173]
    ds_write_b64 v106, v[174:175] offset:512
    s_waitcnt lgkmcnt(0)
    ds_read_b128 v[160:163], v105
    s_waitcnt lgkmcnt(0)
    s_mov_b64 exec, 1
    ds_add_u32 v31, v30 offset:44
    s_mov_b64 exec, -1
    s_waitcnt vmcnt(6) lgkmcnt(0)
    s_barrier
L_q:
    ds_read_b32 v54, v31 offset:4
    ds_read_b32 v55, v31 offset:8
    ds_read_b64_tr_b16 v[112:113], v61 offset:0
    ds_read_b64_tr_b16 v[114:115], v61 offset:112
    ds_read_b128 v[116:119], v57 offset:0
    ds_read_b64_tr_b16 v[120:121], v61 offset:448
    ds_read_b64_tr_b16 v[122:123], v61 offset:560
    ds_read_b128 v[124:127], v58 offset:0
    ds_read_b64_tr_b16 v[128:129], v61 offset:896
    ds_read_b64_tr_b16 v[130:131], v61 offset:1008
    ds_read_b128 v[132:135], v59 offset:0
    ds_read_b64_tr_b16 v[136:137], v61 offset:1344
    ds_read_b64_tr_b16 v[138:139], v61 offset:1456
    ds_read_b128 v[140:143], v60 offset:0
    s_waitcnt lgkmcnt(9)
    v_mfma_f32_32x32x16_bf16 v[32:47], v[112:115], v[116:119], 0
    ds_read_b64_tr_b16 v[144:145], v61 offset:1792
    ds_read_b64_tr_b16 v[146:147], v61 offset:1904
    ds_read_b128 v[148:151], v57 offset:8192
    s_waitcnt lgkmcnt(9)
    v_mfma_f32_32x32x16_bf16 v[32:47], v[120:123], v[124:127], v[32:47]
    ds_read_b64_tr_b16 v[152:153], v61 offset:2240
    ds_read_b64_tr_b16 v[154:155], v61 offset:2352
    ds_read_b128 v[156:159], v58 offset:8192
    s_waitcnt lgkmcnt(9)
    v_mfma_f32_32x32x16_bf16 v[32:47], v[128:131], v[132:135], v[32:47]
    ds_read_b64_tr_b16 v[112:113], v61 offset:2688
    ds_read_b64_tr_b16 v[114:115], v61 offset:2800
    ds_read_b128 v[116:119], v59 offset:8192
    s_waitcnt lgkmcnt(9)
    v_mfma_f32_32x32x16_bf16 v[32:47], v[136:139], v[140:143], v[32:47]
    ds_read_b64_tr_b16 v[120:121], v61 offset:3136
    ds_read_b64_tr_b16 v[122:123], v61 offset:3248
    ds_read_b128 v[124:127], v60 offset:8192
    s_waitcnt lgkmcnt(9)
    v_mfma_f32_32x32x16_bf16 v[32:47], v[144:147], v[148:151], v[32:47]
    ds_read_b64_tr_b16 v[128:129], v61 offset:3584
    ds_read_b64_tr_b16 v[130:131], v61 offset:3696
    ds_read_b128 v[132:135], v57 offset:16384
    s_waitcnt lgkmcnt(9)
    v_mfma_f32_32x32x16_bf16 v[32:47], v[152:155], v[156:159], v[32:47]
    ds_read_b64_tr_b16 v[136:137], v61 offset:4032
    ds_read_b64_tr_b16 v[138:139], v61 offset:4144
    ds_read_b128 v[140:143], v58 offset:16384
    s_waitcnt lgkmcnt(9)
    v_mfma_f32_32x32x16_bf16 v[32:47], v[112:115], v[116:119], v[32:47]
    ds_read_b64_tr_b16 v[144:145], v61 offset:4480
    ds_read_b64_tr_b16 v[146:147], v61 offset:4592
    ds_read_b128 v[148:151], v59 offset:16384
    s_waitcnt lgkmcnt(9)
    v_mfma_f32_32x32x16_bf16 v[32:47], v[120:123], v[124:127], v[32:47]
    ds_read_b64_tr_b16 v[152:153], v61 offset:4928
    ds_read_b64_tr_b16 v[154:155], v61 offset:5040
    ds_read_b128 v[156:159], v60 offset:16384
    s_waitcnt lgkmcnt(9)
    v_mfma_f32_32x32x16_bf16 v[32:47], v[128:131], v[132:135], v[32:47]
    buffer_store_dwordx4 v[160:163], v107, s[44:47], 0 offen sc1
    ds_read_b64_tr_b16 v[112:113], v61 offset:5376
    ds_read_b64_tr_b16 v[114:115], v61 offset:5488
    ds_read_b128 v[116:119], v57 offset:24576
    s_waitcnt lgkmcnt(9)
    v_mfma_f32_32x32x16_bf16 v[32:47], v[136:139], v[140:143], v[32:47]
    buffer_store_dwordx4 v[100:103], v251, s[44:47], 0 offen sc1
    ds_read_b64_tr_b16 v[120:121], v61 offset:5824
    ds_read_b64_tr_b16 v[122:123], v61 offset:5936
    ds_read_b128 v[124:127], v58 offset:24576
    s_waitcnt lgkmcnt(9)
    v_mfma_f32_32x32x16_bf16 v[32:47], v[144:147], v[148:151], v[32:47]
    ds_read_b64_tr_b16 v[128:129], v61 offset:6272
    ds_read_b64_tr_b16 v[130:131], v61 offset:6384
    ds_read_b128 v[132:135], v59 offset:24576
    s_waitcnt lgkmcnt(9)
    v_mfma_f32_32x32x16_bf16 v[32:47], v[152:155], v[156:159], v[32:47]
    ds_read_b64_tr_b16 v[136:137], v61 offset:6720
    ds_read_b64_tr_b16 v[138:139], v61 offset:6832
    ds_read_b128 v[140:143], v60 offset:24576
    s_waitcnt lgkmcnt(9)
    v_mfma_f32_32x32x16_bf16 v[32:47], v[112:115], v[116:119], v[32:47]
    ds_read_b64_tr_b16 v[144:145], v61 offset:7168
    ds_read_b64_tr_b16 v[146:147], v61 offset:7280
    ds_read_b128 v[148:151], v57 offset:32768
    s_waitcnt lgkmcnt(9)
    v_mfma_f32_32x32x16_bf16 v[32:47], v[120:123], v[124:127], v[32:47]
    ds_read_b64_tr_b16 v[152:153], v61 offset:7616
    ds_read_b64_tr_b16 v[154:155], v61 offset:7728
    ds_read_b128 v[156:159], v58 offset:32768
    s_waitcnt lgkmcnt(9)
    v_mfma_f32_32x32x16_bf16 v[32:47], v[128:131], v[132:135], v[32:47]
    ds_read_b64_tr_b16 v[112:113], v61 offset:8064
    ds_read_b64_tr_b16 v[114:115], v61 offset:8176
    ds_read_b128 v[116:119], v59 offset:32768
    s_waitcnt lgkmcnt(9)
    v_mfma_f32_32x32x16_bf16 v[32:47], v[136:139], v[140:143], v[32:47]
    ds_read_b64_tr_b16 v[120:121], v61 offset:8512
    ds_read_b64_tr_b16 v[122:123], v61 offset:8624
    ds_read_b128 v[124:127], v60 offset:32768
    s_waitcnt lgkmcnt(9)
    v_mfma_f32_32x32x16_bf16 v[32:47], v[144:147], v[148:151], v[32:47]
    ds_read_b64_tr_b16 v[128:129], v61 offset:8960
    ds_read_b64_tr_b16 v[130:131], v61 offset:9072
    ds_read_b128 v[132:135], v57 offset:40960
    s_waitcnt lgkmcnt(9)
    v_mfma_f32_32x32x16_bf16 v[32:47], v[152:155], v[156:159], v[32:47]
    ds_read_b64_tr_b16 v[136:137], v61 offset:9408
    ds_read_b64_tr_b16 v[138:139], v61 offset:9520
    ds_read_b128 v[140:143], v58 offset:40960
    s_waitcnt lgkmcnt(9)
    v_mfma_f32_32x32x16_bf16 v[32:47], v[112:115], v[116:119], v[32:47]
    ds_read_b64_tr_b16 v[144:145], v61 offset:9856
    ds_read_b64_tr_b16 v[146:147], v61 offset:9968
    ds_read_b128 v[148:151], v59 offset:40960
    s_waitcnt lgkmcnt(9)
    v_mfma_f32_32x32x16_bf16 v[32:47], v[120:123], v[124:127], v[32:47]
    ds_read_b64_tr_b16 v[152:153], v61 offset:10304
    ds_read_b64_tr_b16 v[154:155], v61 offset:10416
    ds_read_b128 v[156:159], v60 offset:40960
    s_waitcnt lgkmcnt(9)
    v_mfma_f32_32x32x16_bf16 v[32:47], v[128:131], v[132:135], v[32:47]
    ds_read_b64_tr_b16 v[112:113], v61 offset:10752
    ds_read_b64_tr_b16 v[114:115], v61 offset:10864
    ds_read_b128 v[116:119], v57 offset:49152
    s_waitcnt lgkmcnt(9)
    v_mfma_f32_32x32x16_bf16 v[32:47], v[136:139], v[140:143], v[32:47]
    ds_read_b64_tr_b16 v[120:121], v61 offset:11200
    ds_read_b64_tr_b16 v[122:123], v61 offset:11312
    ds_read_b128 v[124:127], v58 offset:49152
    s_waitcnt lgkmcnt(9)
    v_mfma_f32_32x32x16_bf16 v[32:47], v[144:147], v[148:151], v[32:47]
    ds_read_b64_tr_b16 v[128:129], v61 offset:11648
    ds_read_b64_tr_b16 v[130:131], v61 offset:11760
    ds_read_b128 v[132:135], v59 offset:49152
    s_waitcnt lgkmcnt(9)
    v_mfma_f32_32x32x16_bf16 v[32:47], v[152:155], v[156:159], v[32:47]
    ds_read_b64_tr_b16 v[136:137], v61 offset:12096
    ds_read_b64_tr_b16 v[138:139], v61 offset:12208
    ds_read_b128 v[140:143], v60 offset:49152
    s_waitcnt lgkmcnt(9)
    v_mfma_f32_32x32x16_bf16 v[32:47], v[112:115], v[116:119], v[32:47]
    s_waitcnt lgkmcnt(6)
    v_mfma_f32_32x32x16_bf16 v[32:47], v[120:123], v[124:127], v[32:47]
    s_waitcnt lgkmcnt(3)
    v_mfma_f32_32x32x16_bf16 v[32:47], v[128:131], v[132:135], v[32:47]
    s_waitcnt lgkmcnt(0)
    v_mfma_f32_32x32x16_bf16 v[32:47], v[136:139], v[140:143], v[32:47]
    v_mov_b32 v50, 0x58800000
    v_cmp_le_f32 s[68:69], v55, v50
    v_mov_b32 v50, 0x30800000
    v_cmp_ge_f32 s[66:67], v55, v50
    v_mov_b32 v52, 0
    v_mov_b32 v50, 0x43e49249
    s_and_b64 s[66:67], s[66:67], s[68:69]
L_ms3:
    ds_read_b32 v53, v31 offset:44
    s_waitcnt lgkmcnt(0)
    v_cmp_gt_u32 vcc, 4, v53
    s_cbranch_vccnz L_ms3
    s_nop 0
    v_cvt_pk_bf16_f32 v8, v32, v33
    v_cvt_pk_bf16_f32 v9, v34, v35
    v_cvt_pk_bf16_f32 v10, v36, v37
    v_cvt_pk_bf16_f32 v11, v38, v39
    v_cvt_pk_bf16_f32 v12, v40, v41
    v_cvt_pk_bf16_f32 v13, v42, v43
    v_cvt_pk_bf16_f32 v14, v44, v45
    v_cvt_pk_bf16_f32 v15, v46, v47
    s_mov_b32 exec_lo, 0
    v_mov_b32 v14, 0
    v_mov_b32 v15, 0
    s_mov_b32 exec_lo, -1
    ds_write_b128 v62, v[8:11]
    ds_write_b128 v62, v[12:15] offset:1024
    v_dot2c_f32_bf16 v52, v8, v8
    v_dot2c_f32_bf16 v52, v9, v9
    v_dot2c_f32_bf16 v52, v10, v10
    v_dot2c_f32_bf16 v52, v11, v11
    v_dot2c_f32_bf16 v52, v12, v12
    v_dot2c_f32_bf16 v52, v13, v13
    v_dot2c_f32_bf16 v52, v14, v14
    v_dot2c_f32_bf16 v52, v15, v15
    s_nop 2
    v_mul_f32 v52, v52, v54
    v_cmp_le_f32 vcc, v52, v50
    s_nop 0
    s_and_b64 vcc, vcc, s[66:67]
    s_cmp_eq_u64 vcc, -1
    s_cbranch_scc1 L_safe_ne
    ds_write_b32 v31, v30
L_safe_ne:
    s_waitcnt vmcnt(2) lgkmcnt(0)
    s_barrier
    s_branch L_attn
L_vy:
    s_waitcnt vmcnt(0)
    s_barrier
    ds_write_b128 v104, v[172:175]
    ds_write_b128 v104, v[176:179] offset:1024
    buffer_load_dwordx4 v[240:243], v250, s[44:47], 0 offen offset:0 sc1
    buffer_load_dwordx4 v[244:247], v250, s[44:47], 0 offen offset:1024 sc1
    s_mov_b32 m0, s100
    s_nop 0
    buffer_load_dwordx4 v97, s[44:47], 0 offen sc1 lds
    buffer_load_dwordx4 v97, s[44:47], 0 offen offset:1024 sc1 lds
    s_add_u32 m0, s100, 8192
    s_sub_u32 s100, s3, s100
    buffer_load_dwordx4 v99, s[44:47], 0 offen sc1 lds
    buffer_load_dwordx4 v99, s[44:47], 0 offen offset:1024 sc1 lds
    s_waitcnt lgkmcnt(0)
    s_mov_b64 exec, 1
    ds_add_u32 v31, v30 offset:20
    s_mov_b64 exec, -1
L_vs4:
    ds_read_b32 v32, v31 offset:20
    s_waitcnt lgkmcnt(0)
    v_cmp_gt_u32 vcc, 4, v32
    s_cbranch_vccnz L_vs4
    ds_read_b128 v[172:175], v105
    ds_read_b128 v[176:179], v105 offset:1024
    s_waitcnt lgkmcnt(0)
    v_pk_add_f32 v[164:165], v[164:165], v[172:173]
    v_pk_add_f32 v[166:167], v[166:167], v[174:175]
    v_pk_add_f32 v[168:169], v[168:169], v[176:177]
    v_pk_add_f32 v[170:171], v[170:171], v[178:179]
    v_cvt_pk_bf16_f32 v172, v164, v165
    v_cvt_pk_bf16_f32 v173, v166, v167
    v_cvt_pk_bf16_f32 v174, v168, v169
    v_cvt_pk_bf16_f32 v175, v170, v171
    ds_write_b64 v106, v[172:173]
    ds_write_b64 v106, v[174:175] offset:512
    s_waitcnt lgkmcnt(0)
    ds_read_b128 v[160:163], v105
L_vq:
    s_waitcnt lgkmcnt(0)
    buffer_store_dwordx4 v[160:163], v107, s[44:47], 0 offen sc1
    buffer_store_dwordx4 v[100:103], v251, s[44:47], 0 offen sc1
    s_lshl_b32 s66, s95, 11
    s_add_u32 s66, s66, 141056
    v_lshlrev_b32 v16, 4, v1
    v_add_u32 v16, s66, v16
    s_waitcnt vmcnt(2) lgkmcnt(0)
    s_barrier
    ds_read_b128 v[8:11], v16
    ds_read_b128 v[12:15], v16 offset:1024
L_attn:
    ds_read_b32 v112, v31
    s_waitcnt lgkmcnt(1)
    v_mfma_f32_32x32x16_bf16 v[32:47], v[240:243], v[8:11], v[80:95]
    v_mfma_f32_32x32x16_bf16 v[32:47], v[244:247], v[12:15], v[32:47]
    ds_read_b128 v[16:19], v96 offset:8192
    ds_read_b128 v[240:243], v96 offset:0
    ds_read_b128 v[244:247], v96 offset:1024
    ds_read_b128 v[20:23], v96 offset:9216
    s_getreg_b32 s70, hwreg(HW_REG_XCC_ID, 0, 4)
    s_mov_b32 s99, 0
    s_mov_b32 s98, 0
    s_waitcnt lgkmcnt(4)
    v_cmp_eq_u32 vcc, 0, v112
    s_waitcnt lgkmcnt(0)
    s_cbranch_vccz L_slow
L_fast:
    s_mov_b32 m0, s100
    s_add_u32 s99, s99, 8192
    buffer_load_dwordx4 v97, s[44:47], s99 offen sc1 lds
    buffer_load_dwordx4 v97, s[44:47], s99 offen offset:1024 sc1 lds
    s_lshl_b32 s66, s48, 7
    s_add_u32 s66, s66, 9568256
    s_cmp_eq_u32 s60, 0
    s_cselect_b32 s66, s66, -1
    v_mov_b32 v254, s66
    v_mov_b32 v2, s63
    v_mov_b32 v3, s70
    v_mov_b32 v113, 0
    s_setprio 2
    ds_read_b128 v[24:27], v96 offset:10240
    v_exp_f32 v32, v32
    v_exp_f32 v33, v33
    v_exp_f32 v34, v34
    v_exp_f32 v35, v35
    v_mfma_f32_32x32x16_bf16 v[48:63], v[240:243], v[8:11], v[80:95]
    ds_read_b128 v[240:243], v96 offset:2048
    v_exp_f32 v36, v36
    v_exp_f32 v37, v37
    v_exp_f32 v38, v38
    v_exp_f32 v39, v39
    v_mfma_f32_32x32x16_bf16 v[48:63], v[244:247], v[12:15], v[48:63]
    ds_read_b128 v[244:247], v96 offset:3072
    v_exp_f32 v40, v40
    v_exp_f32 v41, v41
    v_exp_f32 v42, v42
    v_exp_f32 v43, v43
    v_smfmac_f32_32x32x32_bf16 v[64:79], v[16:19], v[32:39], v98
    ds_read_b128 v[28:31], v96 offset:11264
    s_add_u32 m0, s100, 8192
    s_sub_u32 s100, s3, s100
    buffer_load_dwordx4 v99, s[44:47], s99 offen sc1 lds
    v_exp_f32 v44, v44
    v_exp_f32 v45, v45
    v_exp_f32 v46, v46
    v_exp_f32 v47, v47
    s_waitcnt lgkmcnt(1)
    s_setprio 1
    v_smfmac_f32_32x32x32_bf16 v[64:79], v[20:23], v[40:47], v98
    ds_read_b128 v[16:19], v96 offset:12288
    v_exp_f32 v48, v48
    v_exp_f32 v49, v49
    v_exp_f32 v50, v50
    v_exp_f32 v51, v51
    v_mfma_f32_32x32x16_bf16 v[32:47], v[240:243], v[8:11], v[80:95]
    ds_read_b128 v[240:243], v96 offset:4096
    v_exp_f32 v52, v52
    v_exp_f32 v53, v53
    v_exp_f32 v54, v54
    v_exp_f32 v55, v55
    v_mfma_f32_32x32x16_bf16 v[32:47], v[244:247], v[12:15], v[32:47]
    ds_read_b128 v[244:247], v96 offset:5120
    v_exp_f32 v56, v56
    v_exp_f32 v57, v57
    v_exp_f32 v58, v58
    v_exp_f32 v59, v59
    v_smfmac_f32_32x32x32_bf16 v[64:79], v[24:27], v[48:55], v98
    ds_read_b128 v[20:23], v96 offset:13312
    buffer_load_dwordx4 v99, s[44:47], s99 offen offset:1024 sc1 lds
    v_exp_f32 v60, v60
    v_exp_f32 v61, v61
    v_exp_f32 v62, v62
    v_exp_f32 v63, v63
    s_waitcnt lgkmcnt(1)
    s_setprio 0
    v_smfmac_f32_32x32x32_bf16 v[64:79], v[28:31], v[56:63], v98
    ds_read_b128 v[24:27], v96 offset:14336
    v_exp_f32 v32, v32
    v_exp_f32 v33, v33
    v_exp_f32 v34, v34
    v_exp_f32 v35, v35
    v_mfma_f32_32x32x16_bf16 v[48:63], v[240:243], v[8:11], v[80:95]
    ds_read_b128 v[240:243], v96 offset:6144
    v_exp_f32 v36, v36
    v_exp_f32 v37, v37
    v_exp_f32 v38, v38
    v_exp_f32 v39, v39
    v_mfma_f32_32x32x16_bf16 v[48:63], v[244:247], v[12:15], v[48:63]
    ds_read_b128 v[244:247], v96 offset:7168
    v_exp_f32 v40, v40
    v_exp_f32 v41, v41
    v_exp_f32 v42, v42
    v_exp_f32 v43, v43
    v_smfmac_f32_32x32x32_bf16 v[64:79], v[16:19], v[32:39], v98
    ds_read_b128 v[28:31], v96 offset:15360
    v_exp_f32 v44, v44
    v_exp_f32 v45, v45
    v_exp_f32 v46, v46
    v_exp_f32 v47, v47
    s_waitcnt lgkmcnt(0)
    s_setprio 3
    v_smfmac_f32_32x32x32_bf16 v[64:79], v[20:23], v[40:47], v98
    s_waitcnt vmcnt(0)
    s_barrier
    v_sub_u32 v96, v111, v96
    ds_read_b128 v[16:19], v96 offset:8192
    v_exp_f32 v48, v48
    v_exp_f32 v49, v49
    v_exp_f32 v50, v50
    v_exp_f32 v51, v51
    v_mfma_f32_32x32x16_bf16 v[32:47], v[240:243], v[8:11], v[80:95]
    ds_read_b128 v[240:243], v96 offset:0
    s_mov_b32 m0, s100
    s_add_u32 s99, s99, 8192
    buffer_load_dwordx4 v97, s[44:47], s99 offen sc1 lds
    v_exp_f32 v52, v52
    v_exp_f32 v53, v53
    v_exp_f32 v54, v54
    v_exp_f32 v55, v55
    v_mfma_f32_32x32x16_bf16 v[32:47], v[244:247], v[12:15], v[32:47]
    ds_read_b128 v[244:247], v96 offset:1024
    v_exp_f32 v56, v56
    v_exp_f32 v57, v57
    v_exp_f32 v58, v58
    v_exp_f32 v59, v59
    v_smfmac_f32_32x32x32_bf16 v[64:79], v[24:27], v[48:55], v98
    ds_read_b128 v[20:23], v96 offset:9216
    buffer_load_dwordx4 v97, s[44:47], s99 offen offset:1024 sc1 lds
    v_exp_f32 v60, v60
    v_exp_f32 v61, v61
    v_exp_f32 v62, v62
    v_exp_f32 v63, v63
    s_waitcnt lgkmcnt(1)
    s_setprio 2
    v_smfmac_f32_32x32x32_bf16 v[64:79], v[28:31], v[56:63], v98
    ds_read_b128 v[24:27], v96 offset:10240
    v_exp_f32 v32, v32
    v_exp_f32 v33, v33
    v_exp_f32 v34, v34
    v_exp_f32 v35, v35
    v_mfma_f32_32x32x16_bf16 v[48:63], v[240:243], v[8:11], v[80:95]
    ds_read_b128 v[240:243], v96 offset:2048
    v_exp_f32 v36, v36
    v_exp_f32 v37, v37
    v_exp_f32 v38, v38
    v_exp_f32 v39, v39
    v_mfma_f32_32x32x16_bf16 v[48:63], v[244:247], v[12:15], v[48:63]
    ds_read_b128 v[244:247], v96 offset:3072
    ds_write_b32 v253, v113
    v_exp_f32 v40, v40
    v_exp_f32 v41, v41
    v_exp_f32 v42, v42
    v_exp_f32 v43, v43
    v_smfmac_f32_32x32x32_bf16 v[64:79], v[16:19], v[32:39], v98
    ds_read_b128 v[28:31], v96 offset:11264
    s_add_u32 m0, s100, 8192
    s_sub_u32 s100, s3, s100
    buffer_load_dwordx4 v99, s[44:47], s99 offen sc1 lds
    v_exp_f32 v44, v44
    v_exp_f32 v45, v45
    v_exp_f32 v46, v46
    v_exp_f32 v47, v47
    s_waitcnt lgkmcnt(1)
    s_setprio 1
    v_smfmac_f32_32x32x32_bf16 v[64:79], v[20:23], v[40:47], v98
    ds_read_b128 v[16:19], v96 offset:12288
    v_exp_f32 v48, v48
    v_exp_f32 v49, v49
    v_exp_f32 v50, v50
    v_exp_f32 v51, v51
    v_mfma_f32_32x32x16_bf16 v[32:47], v[240:243], v[8:11], v[80:95]
    ds_read_b128 v[240:243], v96 offset:4096
    v_exp_f32 v52, v52
    v_exp_f32 v53, v53
    v_exp_f32 v54, v54
    v_exp_f32 v55, v55
    v_mfma_f32_32x32x16_bf16 v[32:47], v[244:247], v[12:15], v[32:47]
    ds_read_b128 v[244:247], v96 offset:5120
    v_exp_f32 v56, v56
    v_exp_f32 v57, v57
    v_exp_f32 v58, v58
    v_exp_f32 v59, v59
    v_smfmac_f32_32x32x32_bf16 v[64:79], v[24:27], v[48:55], v98
    ds_read_b128 v[20:23], v96 offset:13312
    buffer_load_dwordx4 v99, s[44:47], s99 offen offset:1024 sc1 lds
    v_exp_f32 v60, v60
    v_exp_f32 v61, v61
    v_exp_f32 v62, v62
    v_exp_f32 v63, v63
    s_waitcnt lgkmcnt(1)
    s_setprio 0
    v_smfmac_f32_32x32x32_bf16 v[64:79], v[28:31], v[56:63], v98
    ds_read_b128 v[24:27], v96 offset:14336
    v_exp_f32 v32, v32
    v_exp_f32 v33, v33
    v_exp_f32 v34, v34
    v_exp_f32 v35, v35
    v_mfma_f32_32x32x16_bf16 v[48:63], v[240:243], v[8:11], v[80:95]
    ds_read_b128 v[240:243], v96 offset:6144
    s_mov_b64 exec, 1
    buffer_store_dwordx2 v[2:3], v254, s[44:47], 0 offen sc1
    s_mov_b64 exec, -1
    v_exp_f32 v36, v36
    v_exp_f32 v37, v37
    v_exp_f32 v38, v38
    v_exp_f32 v39, v39
    v_mfma_f32_32x32x16_bf16 v[48:63], v[244:247], v[12:15], v[48:63]
    ds_read_b128 v[244:247], v96 offset:7168
    v_exp_f32 v40, v40
    v_exp_f32 v41, v41
    v_exp_f32 v42, v42
    v_exp_f32 v43, v43
    v_smfmac_f32_32x32x32_bf16 v[64:79], v[16:19], v[32:39], v98
    ds_read_b128 v[28:31], v96 offset:15360
    s_mov_b32 m0, s94
    s_add_u32 s94, s94, 1024
    buffer_load_dwordx4 v252, s[36:39], s50 offen lds
    s_add_u32 s50, s50, 28672
    v_exp_f32 v44, v44
    v_exp_f32 v45, v45
    v_exp_f32 v46, v46
    v_exp_f32 v47, v47
    s_waitcnt lgkmcnt(0)
    s_setprio 3
    v_smfmac_f32_32x32x32_bf16 v[64:79], v[20:23], v[40:47], v98
    s_waitcnt vmcnt(2)
    s_barrier
    v_sub_u32 v96, v111, v96
    ds_read_b128 v[16:19], v96 offset:8192
    v_exp_f32 v48, v48
    v_exp_f32 v49, v49
    v_exp_f32 v50, v50
    v_exp_f32 v51, v51
    v_mfma_f32_32x32x16_bf16 v[32:47], v[240:243], v[8:11], v[80:95]
    ds_read_b128 v[240:243], v96 offset:0
    s_mov_b32 m0, s100
    s_add_u32 s99, s99, 8192
    buffer_load_dwordx4 v97, s[44:47], s99 offen sc1 lds
    v_exp_f32 v52, v52
    v_exp_f32 v53, v53
    v_exp_f32 v54, v54
    v_exp_f32 v55, v55
    v_mfma_f32_32x32x16_bf16 v[32:47], v[244:247], v[12:15], v[32:47]
    ds_read_b128 v[244:247], v96 offset:1024
    v_exp_f32 v56, v56
    v_exp_f32 v57, v57
    v_exp_f32 v58, v58
    v_exp_f32 v59, v59
    v_smfmac_f32_32x32x32_bf16 v[64:79], v[24:27], v[48:55], v98
    ds_read_b128 v[20:23], v96 offset:9216
    buffer_load_dwordx4 v97, s[44:47], s99 offen offset:1024 sc1 lds
    v_exp_f32 v60, v60
    v_exp_f32 v61, v61
    v_exp_f32 v62, v62
    v_exp_f32 v63, v63
    s_waitcnt lgkmcnt(1)
    s_setprio 2
    v_smfmac_f32_32x32x32_bf16 v[64:79], v[28:31], v[56:63], v98
    ds_read_b128 v[24:27], v96 offset:10240
    v_exp_f32 v32, v32
    v_exp_f32 v33, v33
    v_exp_f32 v34, v34
    v_exp_f32 v35, v35
    v_mfma_f32_32x32x16_bf16 v[48:63], v[240:243], v[8:11], v[80:95]
    ds_read_b128 v[240:243], v96 offset:2048
    v_exp_f32 v36, v36
    v_exp_f32 v37, v37
    v_exp_f32 v38, v38
    v_exp_f32 v39, v39
    v_mfma_f32_32x32x16_bf16 v[48:63], v[244:247], v[12:15], v[48:63]
    ds_read_b128 v[244:247], v96 offset:3072
    v_exp_f32 v40, v40
    v_exp_f32 v41, v41
    v_exp_f32 v42, v42
    v_exp_f32 v43, v43
    v_smfmac_f32_32x32x32_bf16 v[64:79], v[16:19], v[32:39], v98
    ds_read_b128 v[28:31], v96 offset:11264
    s_add_u32 m0, s100, 8192
    s_sub_u32 s100, s3, s100
    buffer_load_dwordx4 v99, s[44:47], s99 offen sc1 lds
    v_exp_f32 v44, v44
    v_exp_f32 v45, v45
    v_exp_f32 v46, v46
    v_exp_f32 v47, v47
    s_waitcnt lgkmcnt(1)
    s_setprio 1
    v_smfmac_f32_32x32x32_bf16 v[64:79], v[20:23], v[40:47], v98
    ds_read_b128 v[16:19], v96 offset:12288
    v_exp_f32 v48, v48
    v_exp_f32 v49, v49
    v_exp_f32 v50, v50
    v_exp_f32 v51, v51
    v_mfma_f32_32x32x16_bf16 v[32:47], v[240:243], v[8:11], v[80:95]
    ds_read_b128 v[240:243], v96 offset:4096
    v_exp_f32 v52, v52
    v_exp_f32 v53, v53
    v_exp_f32 v54, v54
    v_exp_f32 v55, v55
    v_mfma_f32_32x32x16_bf16 v[32:47], v[244:247], v[12:15], v[32:47]
    ds_read_b128 v[244:247], v96 offset:5120
    v_exp_f32 v56, v56
    v_exp_f32 v57, v57
    v_exp_f32 v58, v58
    v_exp_f32 v59, v59
    v_smfmac_f32_32x32x32_bf16 v[64:79], v[24:27], v[48:55], v98
    ds_read_b128 v[20:23], v96 offset:13312
    buffer_load_dwordx4 v99, s[44:47], s99 offen offset:1024 sc1 lds
    v_exp_f32 v60, v60
    v_exp_f32 v61, v61
    v_exp_f32 v62, v62
    v_exp_f32 v63, v63
    s_waitcnt lgkmcnt(1)
    s_setprio 0
    v_smfmac_f32_32x32x32_bf16 v[64:79], v[28:31], v[56:63], v98
    ds_read_b128 v[24:27], v96 offset:14336
    v_exp_f32 v32, v32
    v_exp_f32 v33, v33
    v_exp_f32 v34, v34
    v_exp_f32 v35, v35
    v_mfma_f32_32x32x16_bf16 v[48:63], v[240:243], v[8:11], v[80:95]
    ds_read_b128 v[240:243], v96 offset:6144
    v_exp_f32 v36, v36
    v_exp_f32 v37, v37
    v_exp_f32 v38, v38
    v_exp_f32 v39, v39
    v_mfma_f32_32x32x16_bf16 v[48:63], v[244:247], v[12:15], v[48:63]
    ds_read_b128 v[244:247], v96 offset:7168
    v_exp_f32 v40, v40
    v_exp_f32 v41, v41
    v_exp_f32 v42, v42
    v_exp_f32 v43, v43
    v_smfmac_f32_32x32x32_bf16 v[64:79], v[16:19], v[32:39], v98
    ds_read_b128 v[28:31], v96 offset:15360
    s_mov_b32 m0, s94
    s_add_u32 s94, s94, 1024
    buffer_load_dwordx4 v252, s[36:39], s50 offen lds
    s_add_u32 s50, s50, 28672
    v_exp_f32 v44, v44
    v_exp_f32 v45, v45
    v_exp_f32 v46, v46
    v_exp_f32 v47, v47
    s_waitcnt lgkmcnt(0)
    s_setprio 3
    v_smfmac_f32_32x32x32_bf16 v[64:79], v[20:23], v[40:47], v98
    s_waitcnt vmcnt(1)
    s_barrier
    v_sub_u32 v96, v111, v96
    ds_read_b128 v[16:19], v96 offset:8192
    v_exp_f32 v48, v48
    v_exp_f32 v49, v49
    v_exp_f32 v50, v50
    v_exp_f32 v51, v51
    v_mfma_f32_32x32x16_bf16 v[32:47], v[240:243], v[8:11], v[80:95]
    ds_read_b128 v[240:243], v96 offset:0
    s_mov_b32 m0, s100
    s_add_u32 s99, s99, 8192
    buffer_load_dwordx4 v97, s[44:47], s99 offen sc1 lds
    v_exp_f32 v52, v52
    v_exp_f32 v53, v53
    v_exp_f32 v54, v54
    v_exp_f32 v55, v55
    v_mfma_f32_32x32x16_bf16 v[32:47], v[244:247], v[12:15], v[32:47]
    ds_read_b128 v[244:247], v96 offset:1024
    v_exp_f32 v56, v56
    v_exp_f32 v57, v57
    v_exp_f32 v58, v58
    v_exp_f32 v59, v59
    v_smfmac_f32_32x32x32_bf16 v[64:79], v[24:27], v[48:55], v98
    ds_read_b128 v[20:23], v96 offset:9216
    buffer_load_dwordx4 v97, s[44:47], s99 offen offset:1024 sc1 lds
    v_exp_f32 v60, v60
    v_exp_f32 v61, v61
    v_exp_f32 v62, v62
    v_exp_f32 v63, v63
    s_waitcnt lgkmcnt(1)
    s_setprio 2
    v_smfmac_f32_32x32x32_bf16 v[64:79], v[28:31], v[56:63], v98
    ds_read_b128 v[24:27], v96 offset:10240
    v_exp_f32 v32, v32
    v_exp_f32 v33, v33
    v_exp_f32 v34, v34
    v_exp_f32 v35, v35
    v_mfma_f32_32x32x16_bf16 v[48:63], v[240:243], v[8:11], v[80:95]
    ds_read_b128 v[240:243], v96 offset:2048
    v_exp_f32 v36, v36
    v_exp_f32 v37, v37
    v_exp_f32 v38, v38
    v_exp_f32 v39, v39
    v_mfma_f32_32x32x16_bf16 v[48:63], v[244:247], v[12:15], v[48:63]
    ds_read_b128 v[244:247], v96 offset:3072
    v_exp_f32 v40, v40
    v_exp_f32 v41, v41
    v_exp_f32 v42, v42
    v_exp_f32 v43, v43
    v_smfmac_f32_32x32x32_bf16 v[64:79], v[16:19], v[32:39], v98
    ds_read_b128 v[28:31], v96 offset:11264
    s_add_u32 m0, s100, 8192
    s_sub_u32 s100, s3, s100
    buffer_load_dwordx4 v99, s[44:47], s99 offen sc1 lds
    v_exp_f32 v44, v44
    v_exp_f32 v45, v45
    v_exp_f32 v46, v46
    v_exp_f32 v47, v47
    s_waitcnt lgkmcnt(1)
    s_setprio 1
    v_smfmac_f32_32x32x32_bf16 v[64:79], v[20:23], v[40:47], v98
    ds_read_b128 v[16:19], v96 offset:12288
    v_exp_f32 v48, v48
    v_exp_f32 v49, v49
    v_exp_f32 v50, v50
    v_exp_f32 v51, v51
    v_mfma_f32_32x32x16_bf16 v[32:47], v[240:243], v[8:11], v[80:95]
    ds_read_b128 v[240:243], v96 offset:4096
    v_exp_f32 v52, v52
    v_exp_f32 v53, v53
    v_exp_f32 v54, v54
    v_exp_f32 v55, v55
    v_mfma_f32_32x32x16_bf16 v[32:47], v[244:247], v[12:15], v[32:47]
    ds_read_b128 v[244:247], v96 offset:5120
    v_exp_f32 v56, v56
    v_exp_f32 v57, v57
    v_exp_f32 v58, v58
    v_exp_f32 v59, v59
    v_smfmac_f32_32x32x32_bf16 v[64:79], v[24:27], v[48:55], v98
    ds_read_b128 v[20:23], v96 offset:13312
    buffer_load_dwordx4 v99, s[44:47], s99 offen offset:1024 sc1 lds
    v_exp_f32 v60, v60
    v_exp_f32 v61, v61
    v_exp_f32 v62, v62
    v_exp_f32 v63, v63
    s_waitcnt lgkmcnt(1)
    s_setprio 0
    v_smfmac_f32_32x32x32_bf16 v[64:79], v[28:31], v[56:63], v98
    ds_read_b128 v[24:27], v96 offset:14336
    v_exp_f32 v32, v32
    v_exp_f32 v33, v33
    v_exp_f32 v34, v34
    v_exp_f32 v35, v35
    v_mfma_f32_32x32x16_bf16 v[48:63], v[240:243], v[8:11], v[80:95]
    ds_read_b128 v[240:243], v96 offset:6144
    v_exp_f32 v36, v36
    v_exp_f32 v37, v37
    v_exp_f32 v38, v38
    v_exp_f32 v39, v39
    v_mfma_f32_32x32x16_bf16 v[48:63], v[244:247], v[12:15], v[48:63]
    ds_read_b128 v[244:247], v96 offset:7168
    v_exp_f32 v40, v40
    v_exp_f32 v41, v41
    v_exp_f32 v42, v42
    v_exp_f32 v43, v43
    v_smfmac_f32_32x32x32_bf16 v[64:79], v[16:19], v[32:39], v98
    ds_read_b128 v[28:31], v96 offset:15360
    s_mov_b32 m0, s94
    s_add_u32 s94, s94, 1024
    buffer_load_dwordx4 v252, s[36:39], s50 offen lds
    s_add_u32 s50, s50, 28672
    v_exp_f32 v44, v44
    v_exp_f32 v45, v45
    v_exp_f32 v46, v46
    v_exp_f32 v47, v47
    s_waitcnt lgkmcnt(0)
    s_setprio 3
    v_smfmac_f32_32x32x32_bf16 v[64:79], v[20:23], v[40:47], v98
    s_waitcnt vmcnt(1)
    s_barrier
    v_sub_u32 v96, v111, v96
    ds_read_b128 v[16:19], v96 offset:8192
    v_exp_f32 v48, v48
    v_exp_f32 v49, v49
    v_exp_f32 v50, v50
    v_exp_f32 v51, v51
    v_mfma_f32_32x32x16_bf16 v[32:47], v[240:243], v[8:11], v[80:95]
    ds_read_b128 v[240:243], v96 offset:0
    s_mov_b32 m0, s100
    s_add_u32 s99, s99, 8192
    buffer_load_dwordx4 v97, s[44:47], s99 offen sc1 lds
    v_exp_f32 v52, v52
    v_exp_f32 v53, v53
    v_exp_f32 v54, v54
    v_exp_f32 v55, v55
    v_mfma_f32_32x32x16_bf16 v[32:47], v[244:247], v[12:15], v[32:47]
    ds_read_b128 v[244:247], v96 offset:1024
    v_exp_f32 v56, v56
    v_exp_f32 v57, v57
    v_exp_f32 v58, v58
    v_exp_f32 v59, v59
    v_smfmac_f32_32x32x32_bf16 v[64:79], v[24:27], v[48:55], v98
    ds_read_b128 v[20:23], v96 offset:9216
    buffer_load_dwordx4 v97, s[44:47], s99 offen offset:1024 sc1 lds
    v_exp_f32 v60, v60
    v_exp_f32 v61, v61
    v_exp_f32 v62, v62
    v_exp_f32 v63, v63
    s_waitcnt lgkmcnt(1)
    s_setprio 2
    v_smfmac_f32_32x32x32_bf16 v[64:79], v[28:31], v[56:63], v98
    ds_read_b128 v[24:27], v96 offset:10240
    v_exp_f32 v32, v32
    v_exp_f32 v33, v33
    v_exp_f32 v34, v34
    v_exp_f32 v35, v35
    v_mfma_f32_32x32x16_bf16 v[48:63], v[240:243], v[8:11], v[80:95]
    ds_read_b128 v[240:243], v96 offset:2048
    v_exp_f32 v36, v36
    v_exp_f32 v37, v37
    v_exp_f32 v38, v38
    v_exp_f32 v39, v39
    v_mfma_f32_32x32x16_bf16 v[48:63], v[244:247], v[12:15], v[48:63]
    ds_read_b128 v[244:247], v96 offset:3072
    v_exp_f32 v40, v40
    v_exp_f32 v41, v41
    v_exp_f32 v42, v42
    v_exp_f32 v43, v43
    v_smfmac_f32_32x32x32_bf16 v[64:79], v[16:19], v[32:39], v98
    ds_read_b128 v[28:31], v96 offset:11264
    s_add_u32 m0, s100, 8192
    s_sub_u32 s100, s3, s100
    buffer_load_dwordx4 v99, s[44:47], s99 offen sc1 lds
    v_exp_f32 v44, v44
    v_exp_f32 v45, v45
    v_exp_f32 v46, v46
    v_exp_f32 v47, v47
    s_waitcnt lgkmcnt(1)
    s_setprio 1
    v_smfmac_f32_32x32x32_bf16 v[64:79], v[20:23], v[40:47], v98
    ds_read_b128 v[16:19], v96 offset:12288
    v_exp_f32 v48, v48
    v_exp_f32 v49, v49
    v_exp_f32 v50, v50
    v_exp_f32 v51, v51
    v_mfma_f32_32x32x16_bf16 v[32:47], v[240:243], v[8:11], v[80:95]
    ds_read_b128 v[240:243], v96 offset:4096
    v_exp_f32 v52, v52
    v_exp_f32 v53, v53
    v_exp_f32 v54, v54
    v_exp_f32 v55, v55
    v_mfma_f32_32x32x16_bf16 v[32:47], v[244:247], v[12:15], v[32:47]
    ds_read_b128 v[244:247], v96 offset:5120
    v_exp_f32 v56, v56
    v_exp_f32 v57, v57
    v_exp_f32 v58, v58
    v_exp_f32 v59, v59
    v_smfmac_f32_32x32x32_bf16 v[64:79], v[24:27], v[48:55], v98
    ds_read_b128 v[20:23], v96 offset:13312
    buffer_load_dwordx4 v99, s[44:47], s99 offen offset:1024 sc1 lds
    v_exp_f32 v60, v60
    v_exp_f32 v61, v61
    v_exp_f32 v62, v62
    v_exp_f32 v63, v63
    s_waitcnt lgkmcnt(1)
    s_setprio 0
    v_smfmac_f32_32x32x32_bf16 v[64:79], v[28:31], v[56:63], v98
    ds_read_b128 v[24:27], v96 offset:14336
    v_exp_f32 v32, v32
    v_exp_f32 v33, v33
    v_exp_f32 v34, v34
    v_exp_f32 v35, v35
    v_mfma_f32_32x32x16_bf16 v[48:63], v[240:243], v[8:11], v[80:95]
    ds_read_b128 v[240:243], v96 offset:6144
    buffer_load_dwordx2 v[104:105], v4, s[44:47], 0 offen sc1
    v_exp_f32 v36, v36
    v_exp_f32 v37, v37
    v_exp_f32 v38, v38
    v_exp_f32 v39, v39
    v_mfma_f32_32x32x16_bf16 v[48:63], v[244:247], v[12:15], v[48:63]
    ds_read_b128 v[244:247], v96 offset:7168
    v_exp_f32 v40, v40
    v_exp_f32 v41, v41
    v_exp_f32 v42, v42
    v_exp_f32 v43, v43
    v_smfmac_f32_32x32x32_bf16 v[64:79], v[16:19], v[32:39], v98
    ds_read_b128 v[28:31], v96 offset:15360
    s_mov_b32 m0, s94
    s_add_u32 s94, s94, 1024
    buffer_load_dwordx4 v252, s[36:39], s50 offen lds
    s_add_u32 s50, s50, 28672
    v_exp_f32 v44, v44
    v_exp_f32 v45, v45
    v_exp_f32 v46, v46
    v_exp_f32 v47, v47
    s_waitcnt lgkmcnt(0)
    s_setprio 3
    v_smfmac_f32_32x32x32_bf16 v[64:79], v[20:23], v[40:47], v98
    s_waitcnt vmcnt(2)
    s_barrier
    v_sub_u32 v96, v111, v96
    ds_read_b128 v[16:19], v96 offset:8192
    v_exp_f32 v48, v48
    v_exp_f32 v49, v49
    v_exp_f32 v50, v50
    v_exp_f32 v51, v51
    v_mfma_f32_32x32x16_bf16 v[32:47], v[240:243], v[8:11], v[80:95]
    ds_read_b128 v[240:243], v96 offset:0
    s_mov_b32 m0, s100
    s_add_u32 s99, s99, 8192
    buffer_load_dwordx4 v97, s[44:47], s99 offen sc1 lds
    v_exp_f32 v52, v52
    v_exp_f32 v53, v53
    v_exp_f32 v54, v54
    v_exp_f32 v55, v55
    v_mfma_f32_32x32x16_bf16 v[32:47], v[244:247], v[12:15], v[32:47]
    ds_read_b128 v[244:247], v96 offset:1024
    v_exp_f32 v56, v56
    v_exp_f32 v57, v57
    v_exp_f32 v58, v58
    v_exp_f32 v59, v59
    v_smfmac_f32_32x32x32_bf16 v[64:79], v[24:27], v[48:55], v98
    ds_read_b128 v[20:23], v96 offset:9216
    buffer_load_dwordx4 v97, s[44:47], s99 offen offset:1024 sc1 lds
    v_exp_f32 v60, v60
    v_exp_f32 v61, v61
    v_exp_f32 v62, v62
    v_exp_f32 v63, v63
    s_waitcnt lgkmcnt(1)
    s_setprio 2
    v_smfmac_f32_32x32x32_bf16 v[64:79], v[28:31], v[56:63], v98
    ds_read_b128 v[24:27], v96 offset:10240
    v_exp_f32 v32, v32
    v_exp_f32 v33, v33
    v_exp_f32 v34, v34
    v_exp_f32 v35, v35
    v_mfma_f32_32x32x16_bf16 v[48:63], v[240:243], v[8:11], v[80:95]
    ds_read_b128 v[240:243], v96 offset:2048
    v_exp_f32 v36, v36
    v_exp_f32 v37, v37
    v_exp_f32 v38, v38
    v_exp_f32 v39, v39
    v_mfma_f32_32x32x16_bf16 v[48:63], v[244:247], v[12:15], v[48:63]
    ds_read_b128 v[244:247], v96 offset:3072
    v_exp_f32 v40, v40
    v_exp_f32 v41, v41
    v_exp_f32 v42, v42
    v_exp_f32 v43, v43
    v_smfmac_f32_32x32x32_bf16 v[64:79], v[16:19], v[32:39], v98
    ds_read_b128 v[28:31], v96 offset:11264
    s_add_u32 m0, s100, 8192
    s_sub_u32 s100, s3, s100
    buffer_load_dwordx4 v99, s[44:47], s99 offen sc1 lds
    v_exp_f32 v44, v44
    v_exp_f32 v45, v45
    v_exp_f32 v46, v46
    v_exp_f32 v47, v47
    s_waitcnt lgkmcnt(1)
    s_setprio 1
    v_smfmac_f32_32x32x32_bf16 v[64:79], v[20:23], v[40:47], v98
    ds_read_b128 v[16:19], v96 offset:12288
    v_exp_f32 v48, v48
    v_exp_f32 v49, v49
    v_exp_f32 v50, v50
    v_exp_f32 v51, v51
    v_mfma_f32_32x32x16_bf16 v[32:47], v[240:243], v[8:11], v[80:95]
    ds_read_b128 v[240:243], v96 offset:4096
    v_exp_f32 v52, v52
    v_exp_f32 v53, v53
    v_exp_f32 v54, v54
    v_exp_f32 v55, v55
    v_mfma_f32_32x32x16_bf16 v[32:47], v[244:247], v[12:15], v[32:47]
    ds_read_b128 v[244:247], v96 offset:5120
    v_exp_f32 v56, v56
    v_exp_f32 v57, v57
    v_exp_f32 v58, v58
    v_exp_f32 v59, v59
    v_smfmac_f32_32x32x32_bf16 v[64:79], v[24:27], v[48:55], v98
    ds_read_b128 v[20:23], v96 offset:13312
    buffer_load_dwordx4 v99, s[44:47], s99 offen offset:1024 sc1 lds
    v_exp_f32 v60, v60
    v_exp_f32 v61, v61
    v_exp_f32 v62, v62
    v_exp_f32 v63, v63
    s_waitcnt lgkmcnt(1)
    s_setprio 0
    v_smfmac_f32_32x32x32_bf16 v[64:79], v[28:31], v[56:63], v98
    ds_read_b128 v[24:27], v96 offset:14336
    v_exp_f32 v32, v32
    v_exp_f32 v33, v33
    v_exp_f32 v34, v34
    v_exp_f32 v35, v35
    v_mfma_f32_32x32x16_bf16 v[48:63], v[240:243], v[8:11], v[80:95]
    ds_read_b128 v[240:243], v96 offset:6144
    s_waitcnt vmcnt(5)
    v_cmp_ne_u32 vcc, s63, v104
    s_nop 0
    s_cbranch_vccnz L_fyretry
L_fyback:
    v_cmp_ne_u32 vcc, s70, v105
    buffer_load_dwordx4 v[100:103], v5, s[44:47], 0 offen sc1
    s_mov_b32 s51, vcc_hi
    v_exp_f32 v36, v36
    v_exp_f32 v37, v37
    v_exp_f32 v38, v38
    v_exp_f32 v39, v39
    v_mfma_f32_32x32x16_bf16 v[48:63], v[244:247], v[12:15], v[48:63]
    ds_read_b128 v[244:247], v96 offset:7168
    buffer_load_dwordx4 v[104:107], v6, s[4:7], 0 offen
    v_exp_f32 v40, v40
    v_exp_f32 v41, v41
    v_exp_f32 v42, v42
    v_exp_f32 v43, v43
    v_smfmac_f32_32x32x32_bf16 v[64:79], v[16:19], v[32:39], v98
    ds_read_b128 v[28:31], v96 offset:15360
    s_mov_b32 m0, s94
    s_add_u32 s94, s94, 1024
    buffer_load_dwordx4 v252, s[36:39], s50 offen lds
    s_add_u32 s50, s50, 28672
    v_exp_f32 v44, v44
    v_exp_f32 v45, v45
    v_exp_f32 v46, v46
    v_exp_f32 v47, v47
    s_waitcnt lgkmcnt(0)
    s_setprio 3
    v_smfmac_f32_32x32x32_bf16 v[64:79], v[20:23], v[40:47], v98
    s_waitcnt vmcnt(3)
    s_barrier
    v_sub_u32 v96, v111, v96
    ds_read_b128 v[16:19], v96 offset:8192
    v_exp_f32 v48, v48
    v_exp_f32 v49, v49
    v_exp_f32 v50, v50
    v_exp_f32 v51, v51
    v_mfma_f32_32x32x16_bf16 v[32:47], v[240:243], v[8:11], v[80:95]
    ds_read_b128 v[240:243], v96 offset:0
    s_mov_b32 m0, s100
    s_add_u32 s99, s99, 8192
    buffer_load_dwordx4 v97, s[44:47], s99 offen sc1 lds
    v_exp_f32 v52, v52
    v_exp_f32 v53, v53
    v_exp_f32 v54, v54
    v_exp_f32 v55, v55
    v_mfma_f32_32x32x16_bf16 v[32:47], v[244:247], v[12:15], v[32:47]
    ds_read_b128 v[244:247], v96 offset:1024
    v_exp_f32 v56, v56
    v_exp_f32 v57, v57
    v_exp_f32 v58, v58
    v_exp_f32 v59, v59
    v_smfmac_f32_32x32x32_bf16 v[64:79], v[24:27], v[48:55], v98
    ds_read_b128 v[20:23], v96 offset:9216
    buffer_load_dwordx4 v97, s[44:47], s99 offen offset:1024 sc1 lds
    v_exp_f32 v60, v60
    v_exp_f32 v61, v61
    v_exp_f32 v62, v62
    v_exp_f32 v63, v63
    s_waitcnt lgkmcnt(1)
    s_setprio 2
    v_smfmac_f32_32x32x32_bf16 v[64:79], v[28:31], v[56:63], v98
    ds_read_b128 v[24:27], v96 offset:10240
    v_exp_f32 v32, v32
    v_exp_f32 v33, v33
    v_exp_f32 v34, v34
    v_exp_f32 v35, v35
    v_mfma_f32_32x32x16_bf16 v[48:63], v[240:243], v[8:11], v[80:95]
    ds_read_b128 v[240:243], v96 offset:2048
    v_exp_f32 v36, v36
    v_exp_f32 v37, v37
    v_exp_f32 v38, v38
    v_exp_f32 v39, v39
    v_mfma_f32_32x32x16_bf16 v[48:63], v[244:247], v[12:15], v[48:63]
    ds_read_b128 v[244:247], v96 offset:3072
    v_exp_f32 v40, v40
    v_exp_f32 v41, v41
    v_exp_f32 v42, v42
    v_exp_f32 v43, v43
    v_smfmac_f32_32x32x32_bf16 v[64:79], v[16:19], v[32:39], v98
    ds_read_b128 v[28:31], v96 offset:11264
    s_add_u32 m0, s100, 8192
    s_sub_u32 s100, s3, s100
    buffer_load_dwordx4 v99, s[44:47], s99 offen sc1 lds
    v_exp_f32 v44, v44
    v_exp_f32 v45, v45
    v_exp_f32 v46, v46
    v_exp_f32 v47, v47
    s_waitcnt lgkmcnt(1)
    s_setprio 1
    v_smfmac_f32_32x32x32_bf16 v[64:79], v[20:23], v[40:47], v98
    ds_read_b128 v[16:19], v96 offset:12288
    v_exp_f32 v48, v48
    v_exp_f32 v49, v49
    v_exp_f32 v50, v50
    v_exp_f32 v51, v51
    v_mfma_f32_32x32x16_bf16 v[32:47], v[240:243], v[8:11], v[80:95]
    ds_read_b128 v[240:243], v96 offset:4096
    v_exp_f32 v52, v52
    v_exp_f32 v53, v53
    v_exp_f32 v54, v54
    v_exp_f32 v55, v55
    v_mfma_f32_32x32x16_bf16 v[32:47], v[244:247], v[12:15], v[32:47]
    ds_read_b128 v[244:247], v96 offset:5120
    v_exp_f32 v56, v56
    v_exp_f32 v57, v57
    v_exp_f32 v58, v58
    v_exp_f32 v59, v59
    v_smfmac_f32_32x32x32_bf16 v[64:79], v[24:27], v[48:55], v98
    ds_read_b128 v[20:23], v96 offset:13312
    buffer_load_dwordx4 v99, s[44:47], s99 offen offset:1024 sc1 lds
    v_exp_f32 v60, v60
    v_exp_f32 v61, v61
    v_exp_f32 v62, v62
    v_exp_f32 v63, v63
    s_waitcnt lgkmcnt(1)
    s_setprio 0
    v_smfmac_f32_32x32x32_bf16 v[64:79], v[28:31], v[56:63], v98
    ds_read_b128 v[24:27], v96 offset:14336
    v_exp_f32 v32, v32
    v_exp_f32 v33, v33
    v_exp_f32 v34, v34
    v_exp_f32 v35, v35
    v_mfma_f32_32x32x16_bf16 v[48:63], v[240:243], v[8:11], v[80:95]
    ds_read_b128 v[240:243], v96 offset:6144
    v_exp_f32 v36, v36
    v_exp_f32 v37, v37
    v_exp_f32 v38, v38
    v_exp_f32 v39, v39
    v_mfma_f32_32x32x16_bf16 v[48:63], v[244:247], v[12:15], v[48:63]
    ds_read_b128 v[244:247], v96 offset:7168
    v_exp_f32 v40, v40
    v_exp_f32 v41, v41
    v_exp_f32 v42, v42
    v_exp_f32 v43, v43
    v_smfmac_f32_32x32x32_bf16 v[64:79], v[16:19], v[32:39], v98
    ds_read_b128 v[28:31], v96 offset:15360
    s_mov_b32 m0, s94
    s_add_u32 s94, s94, 1024
    buffer_load_dwordx4 v252, s[36:39], s50 offen lds
    s_add_u32 s50, s50, 28672
    v_exp_f32 v44, v44
    v_exp_f32 v45, v45
    v_exp_f32 v46, v46
    v_exp_f32 v47, v47
    s_waitcnt lgkmcnt(0)
    s_setprio 3
    v_smfmac_f32_32x32x32_bf16 v[64:79], v[20:23], v[40:47], v98
    s_waitcnt vmcnt(1)
    s_barrier
    v_sub_u32 v96, v111, v96
    ds_read_b128 v[16:19], v96 offset:8192
    v_exp_f32 v48, v48
    v_exp_f32 v49, v49
    v_exp_f32 v50, v50
    v_exp_f32 v51, v51
    v_mfma_f32_32x32x16_bf16 v[32:47], v[240:243], v[8:11], v[80:95]
    ds_read_b128 v[240:243], v96 offset:0
    v_exp_f32 v52, v52
    v_exp_f32 v53, v53
    v_exp_f32 v54, v54
    v_exp_f32 v55, v55
    v_mfma_f32_32x32x16_bf16 v[32:47], v[244:247], v[12:15], v[32:47]
    ds_read_b128 v[244:247], v96 offset:1024
    v_exp_f32 v56, v56
    v_exp_f32 v57, v57
    v_exp_f32 v58, v58
    v_exp_f32 v59, v59
    v_smfmac_f32_32x32x32_bf16 v[64:79], v[24:27], v[48:55], v98
    ds_read_b128 v[20:23], v96 offset:9216
    s_mov_b32 m0, s94
    s_add_u32 s94, s94, 1024
    buffer_load_dwordx4 v252, s[36:39], s50 offen lds
    s_add_u32 s50, s50, 28672
    v_exp_f32 v60, v60
    v_exp_f32 v61, v61
    v_exp_f32 v62, v62
    v_exp_f32 v63, v63
    s_waitcnt lgkmcnt(1)
    s_setprio 2
    v_smfmac_f32_32x32x32_bf16 v[64:79], v[28:31], v[56:63], v98
    ds_read_b128 v[24:27], v96 offset:10240
    v_exp_f32 v32, v32
    v_exp_f32 v33, v33
    v_exp_f32 v34, v34
    v_exp_f32 v35, v35
    v_mfma_f32_32x32x16_bf16 v[48:63], v[240:243], v[8:11], v[80:95]
    ds_read_b128 v[240:243], v96 offset:2048
    v_exp_f32 v36, v36
    v_exp_f32 v37, v37
    v_exp_f32 v38, v38
    v_exp_f32 v39, v39
    v_mfma_f32_32x32x16_bf16 v[48:63], v[244:247], v[12:15], v[48:63]
    ds_read_b128 v[244:247], v96 offset:3072
    ds_write_b128 v7, v[100:103]
    v_exp_f32 v40, v40
    v_exp_f32 v41, v41
    v_exp_f32 v42, v42
    v_exp_f32 v43, v43
    v_smfmac_f32_32x32x32_bf16 v[64:79], v[16:19], v[32:39], v98
    ds_read_b128 v[28:31], v96 offset:11264
    v_exp_f32 v44, v44
    v_exp_f32 v45, v45
    v_exp_f32 v46, v46
    v_exp_f32 v47, v47
    s_waitcnt lgkmcnt(1)
    s_setprio 1
    v_smfmac_f32_32x32x32_bf16 v[64:79], v[20:23], v[40:47], v98
    ds_read_b128 v[16:19], v96 offset:12288
    v_exp_f32 v48, v48
    v_exp_f32 v49, v49
    v_exp_f32 v50, v50
    v_exp_f32 v51, v51
    v_mfma_f32_32x32x16_bf16 v[32:47], v[240:243], v[8:11], v[80:95]
    ds_read_b128 v[240:243], v96 offset:4096
    v_exp_f32 v52, v52
    v_exp_f32 v53, v53
    v_exp_f32 v54, v54
    v_exp_f32 v55, v55
    v_mfma_f32_32x32x16_bf16 v[32:47], v[244:247], v[12:15], v[32:47]
    ds_read_b128 v[244:247], v96 offset:5120
    v_exp_f32 v56, v56
    v_exp_f32 v57, v57
    v_exp_f32 v58, v58
    v_exp_f32 v59, v59
    v_smfmac_f32_32x32x32_bf16 v[64:79], v[24:27], v[48:55], v98
    ds_read_b128 v[20:23], v96 offset:13312
    v_exp_f32 v60, v60
    v_exp_f32 v61, v61
    v_exp_f32 v62, v62
    v_exp_f32 v63, v63
    s_waitcnt lgkmcnt(1)
    s_setprio 0
    v_smfmac_f32_32x32x32_bf16 v[64:79], v[28:31], v[56:63], v98
    ds_read_b128 v[24:27], v96 offset:14336
    v_exp_f32 v32, v32
    v_exp_f32 v33, v33
    v_exp_f32 v34, v34
    v_exp_f32 v35, v35
    v_mfma_f32_32x32x16_bf16 v[48:63], v[240:243], v[8:11], v[80:95]
    ds_read_b128 v[240:243], v96 offset:6144
    v_exp_f32 v36, v36
    v_exp_f32 v37, v37
    v_exp_f32 v38, v38
    v_exp_f32 v39, v39
    v_mfma_f32_32x32x16_bf16 v[48:63], v[244:247], v[12:15], v[48:63]
    ds_read_b128 v[244:247], v96 offset:7168
    v_exp_f32 v40, v40
    v_exp_f32 v41, v41
    v_exp_f32 v42, v42
    v_exp_f32 v43, v43
    v_smfmac_f32_32x32x32_bf16 v[64:79], v[16:19], v[32:39], v98
    ds_read_b128 v[28:31], v96 offset:15360
    v_exp_f32 v44, v44
    v_exp_f32 v45, v45
    v_exp_f32 v46, v46
    v_exp_f32 v47, v47
    s_waitcnt lgkmcnt(0)
    s_setprio 3
    v_smfmac_f32_32x32x32_bf16 v[64:79], v[20:23], v[40:47], v98
    v_exp_f32 v48, v48
    v_exp_f32 v49, v49
    v_exp_f32 v50, v50
    v_exp_f32 v51, v51
    v_exp_f32 v52, v52
    v_exp_f32 v53, v53
    v_exp_f32 v54, v54
    v_exp_f32 v55, v55
    v_exp_f32 v56, v56
    v_exp_f32 v57, v57
    v_smfmac_f32_32x32x32_bf16 v[64:79], v[24:27], v[48:55], v98
    v_exp_f32 v58, v58
    v_exp_f32 v59, v59
    v_exp_f32 v60, v60
    v_exp_f32 v61, v61
    v_exp_f32 v62, v62
    v_exp_f32 v63, v63
    s_nop 1
    v_smfmac_f32_32x32x32_bf16 v[64:79], v[28:31], v[56:63], v98
    s_setprio 0
    s_branch L_tail
L_fyretry:
    s_mov_b32 s71, 0
L_pfy:
    buffer_load_dwordx2 v[104:105], v4, s[44:47], 0 offen sc1
    s_waitcnt vmcnt(0)
    v_cmp_ne_u32 vcc, s63, v104
    s_add_u32 s71, s71, 1
    s_cbranch_vccz L_pfy_ok
    s_cmp_gt_u32 s71, 262144
    s_cbranch_scc1 L_pfy_ok
    s_mov_b64 exec, vcc
    s_sleep 4
    s_branch L_pfy
L_pfy_ok:
    s_mov_b64 exec, -1
    s_branch L_fyback
L_noconv:
    s_mov_b32 exec_hi, 0x00ffffff
    s_add_u32 m0, s56, s98
    s_lshl_b32 s71, s98, 5
    buffer_load_dwordx4 v241, s[28:31], s71 offen lds
    s_add_u32 s98, s98, 896
    s_cmp_eq_u32 s98, 6272
    s_cselect_b32 s98, 0, s98
    s_add_u32 m0, s56, s98
    s_lshl_b32 s71, s98, 5
    buffer_load_dwordx4 v241, s[28:31], s71 offen lds
    s_add_u32 s98, s98, 896
    s_cmp_eq_u32 s98, 6272
    s_cselect_b32 s98, 0, s98
    s_add_u32 m0, s56, s98
    s_lshl_b32 s71, s98, 5
    buffer_load_dwordx4 v241, s[28:31], s71 offen lds
    s_add_u32 s98, s98, 896
    s_cmp_eq_u32 s98, 6272
    s_cselect_b32 s98, 0, s98
    s_add_u32 m0, s56, s98
    s_lshl_b32 s71, s98, 5
    buffer_load_dwordx4 v241, s[28:31], s71 offen lds
    s_add_u32 s98, s98, 896
    s_cmp_eq_u32 s98, 6272
    s_cselect_b32 s98, 0, s98
    s_add_u32 m0, s56, s98
    s_lshl_b32 s71, s98, 5
    buffer_load_dwordx4 v241, s[28:31], s71 offen lds
    s_add_u32 s98, s98, 896
    s_cmp_eq_u32 s98, 6272
    s_cselect_b32 s98, 0, s98
    s_add_u32 m0, s56, s98
    s_lshl_b32 s71, s98, 5
    buffer_load_dwordx4 v241, s[28:31], s71 offen lds
    s_add_u32 s98, s98, 896
    s_cmp_eq_u32 s98, 6272
    s_cselect_b32 s98, 0, s98
    s_add_u32 m0, s56, s98
    s_lshl_b32 s71, s98, 5
    buffer_load_dwordx4 v241, s[28:31], s71 offen lds
    s_add_u32 s98, s98, 896
    s_cmp_eq_u32 s98, 6272
    s_cselect_b32 s98, 0, s98
    s_mov_b32 exec_hi, -1
    s_waitcnt vmcnt(0)
    buffer_load_dwordx3 v[244:246], v242, s[44:47], 0 offen sc1
    s_mov_b32 s71, 0
    s_waitcnt vmcnt(0)
    s_branch L_pfb3_chk
L_pfb3:
    buffer_load_dwordx3 v[244:246], v242, s[44:47], 0 offen sc1
    s_waitcnt vmcnt(0)
L_pfb3_chk:
    v_cmp_ne_u32 vcc, s63, v244
    s_add_u32 s71, s71, 1
    s_cbranch_vccz L_pfb3_ok
    s_cmp_gt_u32 s71, 262144
    s_cbranch_scc1 L_pfb3_ok
    s_mov_b64 exec, vcc
    s_sleep 4
    s_branch L_pfb3
L_pfb3_ok:
    s_mov_b64 exec, -1
    s_cmp_eq_u32 s101, 0
    s_cselect_b64 vcc, -1, 0
    s_lshl_b32 s66, s101, 2
    s_add_u32 s66, s66, 158468
    v_cndmask_b32 v33, v246, v245, vcc
    v_mov_b32 v34, s66
    s_nop 1
    v_max_u32_dpp v33, v33, v33 quad_perm:[1,0,3,2] row_mask:0xf bank_mask:0xf
    s_nop 1
    v_max_u32_dpp v33, v33, v33 quad_perm:[2,3,0,1] row_mask:0xf bank_mask:0xf
    s_nop 1
    v_max_u32_dpp v33, v33, v33 row_half_mirror row_mask:0xf bank_mask:0xf
    s_nop 1
    v_max_u32_dpp v33, v33, v33 row_mirror row_mask:0xf bank_mask:0xf
    v_mov_b32 v32, v33
    s_nop 1
    v_permlane16_swap_b32 v33, v32
    v_max_u32 v33, v33, v32
    v_mov_b32 v32, v33
    s_nop 1
    v_permlane32_swap_b32 v33, v32
    v_max_u32 v33, v33, v32
    s_mov_b64 exec, 1
    ds_max_u32 v34, v33
    s_mov_b64 exec, -1
    v_mov_b32 v107, -1
    s_cmp_ge_u32 s60, 4
    s_cbranch_scc1 L_nc_v
    s_mov_b64 exec, 1
    ds_add_u32 v31, v30 offset:44
    s_mov_b64 exec, -1
    s_waitcnt lgkmcnt(0)
    s_barrier
    buffer_load_dwordx4 v[240:243], v250, s[44:47], 0 offen offset:0 sc1
    buffer_load_dwordx4 v[244:247], v250, s[44:47], 0 offen offset:1024 sc1
    s_mov_b32 m0, s100
    s_nop 0
    buffer_load_dwordx4 v97, s[44:47], 0 offen sc1 lds
    buffer_load_dwordx4 v97, s[44:47], 0 offen offset:1024 sc1 lds
    s_add_u32 m0, s100, 8192
    s_sub_u32 s100, s3, s100
    buffer_load_dwordx4 v99, s[44:47], 0 offen sc1 lds
    buffer_load_dwordx4 v99, s[44:47], 0 offen offset:1024 sc1 lds
    s_branch L_q
L_nc_v:
    s_waitcnt lgkmcnt(0)
    s_barrier
    buffer_load_dwordx4 v[240:243], v250, s[44:47], 0 offen offset:0 sc1
    buffer_load_dwordx4 v[244:247], v250, s[44:47], 0 offen offset:1024 sc1
    s_mov_b32 m0, s100
    s_nop 0
    buffer_load_dwordx4 v97, s[44:47], 0 offen sc1 lds
    buffer_load_dwordx4 v97, s[44:47], 0 offen offset:1024 sc1 lds
    s_add_u32 m0, s100, 8192
    s_sub_u32 s100, s3, s100
    buffer_load_dwordx4 v99, s[44:47], 0 offen sc1 lds
    buffer_load_dwordx4 v99, s[44:47], 0 offen offset:1024 sc1 lds
    s_branch L_vq
L_slow:
    s_nop 7
    s_nop 3
    v_max_f32 v112, v32, v33
    v_max3_f32 v112, v112, v34, v35
    v_max3_f32 v112, v112, v36, v37
    v_max3_f32 v112, v112, v38, v39
    v_max3_f32 v112, v112, v40, v41
    v_max3_f32 v112, v112, v42, v43
    v_max3_f32 v112, v112, v44, v45
    v_max3_f32 v112, v112, v46, v47
L_sloop:
    s_cmp_eq_u32 s98, 7
    s_cbranch_scc1 L_snodma
    s_mov_b32 m0, s100
    s_add_u32 s99, s99, 8192
    buffer_load_dwordx4 v97, s[44:47], s99 offen sc1 lds
    buffer_load_dwordx4 v97, s[44:47], s99 offen offset:1024 sc1 lds
    s_add_u32 m0, s100, 8192
    s_sub_u32 s100, s3, s100
    buffer_load_dwordx4 v99, s[44:47], s99 offen sc1 lds
    buffer_load_dwordx4 v99, s[44:47], s99 offen offset:1024 sc1 lds
L_snodma:
    ds_read_b128 v[240:243], v96 offset:0
    ds_read_b128 v[244:247], v96 offset:1024
    s_waitcnt lgkmcnt(0)
    v_mfma_f32_32x32x16_bf16 v[32:47], v[240:243], v[8:11], 0
    v_mfma_f32_32x32x16_bf16 v[32:47], v[244:247], v[12:15], v[32:47]
    s_nop 7
    s_nop 3
    v_max3_f32 v112, v112, v32, v33
    v_max3_f32 v112, v112, v34, v35
    v_max3_f32 v112, v112, v36, v37
    v_max3_f32 v112, v112, v38, v39
    v_max3_f32 v112, v112, v40, v41
    v_max3_f32 v112, v112, v42, v43
    v_max3_f32 v112, v112, v44, v45
    v_max3_f32 v112, v112, v46, v47
    ds_read_b128 v[240:243], v96 offset:2048
    ds_read_b128 v[244:247], v96 offset:3072
    s_waitcnt lgkmcnt(0)
    v_mfma_f32_32x32x16_bf16 v[32:47], v[240:243], v[8:11], 0
    v_mfma_f32_32x32x16_bf16 v[32:47], v[244:247], v[12:15], v[32:47]
    s_nop 7
    s_nop 3
    v_max3_f32 v112, v112, v32, v33
    v_max3_f32 v112, v112, v34, v35
    v_max3_f32 v112, v112, v36, v37
    v_max3_f32 v112, v112, v38, v39
    v_max3_f32 v112, v112, v40, v41
    v_max3_f32 v112, v112, v42, v43
    v_max3_f32 v112, v112, v44, v45
    v_max3_f32 v112, v112, v46, v47
    ds_read_b128 v[240:243], v96 offset:4096
    ds_read_b128 v[244:247], v96 offset:5120
    s_waitcnt lgkmcnt(0)
    v_mfma_f32_32x32x16_bf16 v[32:47], v[240:243], v[8:11], 0
    v_mfma_f32_32x32x16_bf16 v[32:47], v[244:247], v[12:15], v[32:47]
    s_nop 7
    s_nop 3
    v_max3_f32 v112, v112, v32, v33
    v_max3_f32 v112, v112, v34, v35
    v_max3_f32 v112, v112, v36, v37
    v_max3_f32 v112, v112, v38, v39
    v_max3_f32 v112, v112, v40, v41
    v_max3_f32 v112, v112, v42, v43
    v_max3_f32 v112, v112, v44, v45
    v_max3_f32 v112, v112, v46, v47
    s_cmp_eq_u32 s98, 7
    s_cbranch_scc1 L_sskip
    ds_read_b128 v[240:243], v96 offset:6144
    ds_read_b128 v[244:247], v96 offset:7168
    s_waitcnt lgkmcnt(0)
    v_mfma_f32_32x32x16_bf16 v[32:47], v[240:243], v[8:11], 0
    v_mfma_f32_32x32x16_bf16 v[32:47], v[244:247], v[12:15], v[32:47]
    s_nop 7
    s_nop 3
    v_max3_f32 v112, v112, v32, v33
    v_max3_f32 v112, v112, v34, v35
    v_max3_f32 v112, v112, v36, v37
    v_max3_f32 v112, v112, v38, v39
    v_max3_f32 v112, v112, v40, v41
    v_max3_f32 v112, v112, v42, v43
    v_max3_f32 v112, v112, v44, v45
    v_max3_f32 v112, v112, v46, v47
L_sskip:
    s_waitcnt vmcnt(0)
    s_barrier
    v_sub_u32 v96, v111, v96
    s_add_u32 s98, s98, 1
    s_cmp_lt_u32 s98, 8
    s_cbranch_scc1 L_sloop
    s_mov_b32 m0, s100
    s_nop 0
    buffer_load_dwordx4 v97, s[44:47], 0 offen sc1 lds
    buffer_load_dwordx4 v97, s[44:47], 0 offen offset:1024 sc1 lds
    s_add_u32 m0, s100, 8192
    s_sub_u32 s100, s3, s100
    buffer_load_dwordx4 v99, s[44:47], 0 offen sc1 lds
    buffer_load_dwordx4 v99, s[44:47], 0 offen offset:1024 sc1 lds
    buffer_load_dwordx4 v[240:243], v250, s[44:47], 0 offen offset:0 sc1
    buffer_load_dwordx4 v[244:247], v250, s[44:47], 0 offen offset:1024 sc1
    v_mov_b32 v113, v112
    s_lshl_b32 s66, s60, 8
    s_add_u32 s66, s66, 32768
    v_lshlrev_b32 v114, 2, v1
    v_permlane32_swap_b32 v112, v113
    v_add_u32 v114, s66, v114
    v_max_f32 v112, v112, v113
    v_xor_b32 v115, 1024, v114
    ds_write_b32 v114, v112
    s_waitcnt vmcnt(0) lgkmcnt(0)
    s_barrier
    ds_read_b32 v113, v115
    s_waitcnt lgkmcnt(0)
    v_max_f32 v112, v112, v113
    v_sub_f32 v80, 0, v112
    v_sub_f32 v81, 0, v112
    v_sub_f32 v82, 0, v112
    v_sub_f32 v83, 0, v112
    v_sub_f32 v84, 0, v112
    v_sub_f32 v85, 0, v112
    v_sub_f32 v86, 0, v112
    v_sub_f32 v87, 0, v112
    v_sub_f32 v88, 0, v112
    v_sub_f32 v89, 0, v112
    v_sub_f32 v90, 0, v112
    v_sub_f32 v91, 0, v112
    v_sub_f32 v92, 0, v112
    v_sub_f32 v93, 0, v112
    v_sub_f32 v94, 0, v112
    v_sub_f32 v95, 0, v112
    s_mov_b32 s99, 0
    s_mov_b32 s98, 0
    v_mfma_f32_32x32x16_bf16 v[32:47], v[240:243], v[8:11], v[80:95]
    v_mfma_f32_32x32x16_bf16 v[32:47], v[244:247], v[12:15], v[32:47]
    ds_read_b128 v[16:19], v96 offset:8192
    ds_read_b128 v[240:243], v96 offset:0
    ds_read_b128 v[244:247], v96 offset:1024
    ds_read_b128 v[20:23], v96 offset:9216
    s_nop 7
    s_waitcnt lgkmcnt(0)
    s_branch L_fast
L_tail:
    s_lshl_b32 s68, s101, 5
    s_sub_u32 s68, 64, s68
    v_cmp_gt_u32 s[68:69], s68, v1
    s_mov_b32 s71, 0
    s_cmp_eq_u32 s101, 0
    s_nop 5
    s_cbranch_scc1 L_or0
    ds_write_b128 v248, v[64:67]
    ds_write_b128 v248, v[68:71] offset:1024
    ds_write_b32 v248, v76 offset:2048
    v_mov_b32 v19, v76
    v_mov_b32 v64, v72
    v_mov_b32 v65, v73
    v_mov_b32 v66, v74
    v_mov_b32 v67, v75
    v_mov_b32 v68, v76
    v_mov_b32 v69, v77
    v_mov_b32 v70, v78
    v_mov_b32 v71, v79
    s_branch L_or1
L_or0:
    ds_write_b128 v248, v[72:75]
    ds_write_b128 v248, v[76:79] offset:1024
    ds_write_b32 v248, v76 offset:2048
    v_mov_b32 v19, v76
L_or1:
    s_waitcnt vmcnt(0) lgkmcnt(0)
    s_barrier
    ds_read_b32 v20, v249 offset:2048
    ds_read_b128 v[24:27], v249
    ds_read_b128 v[28:31], v249 offset:1024
    s_waitcnt lgkmcnt(2)
    v_add_f32 v19, v19, v20
    v_rcp_f32 v19, v19
    s_nop 0
    v_mov_b32 v18, v19
    s_waitcnt lgkmcnt(0)
    s_nop 0
    v_permlane32_swap_b32 v18, v19
    v_pk_add_f32 v[64:65], v[64:65], v[24:25]
    v_pk_add_f32 v[66:67], v[66:67], v[26:27]
    v_pk_add_f32 v[68:69], v[68:69], v[28:29]
    v_pk_add_f32 v[70:71], v[70:71], v[30:31]
    v_cndmask_b32 v18, 0, v19, s[68:69]
    v_pk_mul_f32 v[64:65], v[64:65], v[18:19] op_sel:[0,1] op_sel_hi:[1,1]
    v_pk_mul_f32 v[66:67], v[66:67], v[18:19] op_sel:[0,1] op_sel_hi:[1,1]
    v_pk_mul_f32 v[68:69], v[68:69], v[18:19] op_sel:[0,0] op_sel_hi:[1,0]
    v_pk_mul_f32 v[70:71], v[70:71], v[18:19] op_sel:[0,0] op_sel_hi:[1,0]
    v_cvt_pk_bf16_f32 v24, v64, v65
    v_cvt_pk_bf16_f32 v25, v66, v67
    v_cvt_pk_bf16_f32 v26, v68, v69
    v_cvt_pk_bf16_f32 v27, v70, v71
    v_min_u32 v24, -2, v24
    v_min_u32 v25, -2, v25
    v_min_u32 v26, -2, v26
    v_min_u32 v27, -2, v27
    s_cmp_eq_u32 s51, 0
    s_nop 0
    v_permlane32_swap_b32 v24, v26
    v_permlane32_swap_b32 v25, v27
    s_cbranch_scc1 L_osame
    buffer_store_dwordx4 v[24:27], v108, s[44:47], 0 offen sc1
    s_branch L_odone
L_osame:
    buffer_store_dwordx4 v[24:27], v108, s[44:47], 0 offen
L_odone:
    s_cmp_eq_u32 s62, 7
    s_cbranch_scc1 L_fin
    v_bfe_u32 v2, v1, 2, 2
    v_mul_u32_u24 v2, 14400, v2
    v_lshrrev_b32 v3, 4, v1
    v_lshl_add_u32 v2, v3, 8, v2
    v_and_b32 v6, 3, v1
    v_lshl_add_u32 v2, v6, 3, v2
    s_mul_i32 s66, s101, 7168
    s_add_u32 s66, s66, 90624
    v_and_b32 v3, 1, v3
    v_lshlrev_b32 v3, 5, v3
    v_add3_u32 v4, v2, v3, s66
    v_xor_b32 v3, 32, v3
    v_add3_u32 v6, v2, v3, s66
    s_lshl_b32 s66, s61, 16
    s_lshl_b32 s67, s101, 15
    s_add_u32 s66, s66, s67
    s_lshl_b32 s67, s95, 10
    s_add_u32 s66, s66, s67
    s_add_u32 s66, s66, 4194304
    v_lshlrev_b32 v2, 4, v1
    v_add_u32 v2, s66, v2
    v_mov_b32 v80, 0
    v_mov_b32 v81, 0
    v_mov_b32 v82, 0
    v_mov_b32 v83, 0
    v_mov_b32 v84, 0
    v_mov_b32 v85, 0
    v_mov_b32 v86, 0
    v_mov_b32 v87, 0
    ds_read_u16_d16_hi v80, v109 offset:0
    ds_read_u16_d16_hi v81, v109 offset:128
    ds_read_u16_d16_hi v82, v109 offset:256
    ds_read_u16_d16_hi v83, v109 offset:384
    ds_read_u16_d16_hi v84, v109 offset:512
    ds_read_u16_d16_hi v85, v109 offset:640
    ds_read_u16_d16_hi v86, v109 offset:768
    ds_read_u16_d16_hi v87, v109 offset:896
    v_lshlrev_b32 v88, 16, v104
    v_and_b32 v89, 0xffff0000, v104
    v_lshlrev_b32 v90, 16, v105
    v_and_b32 v91, 0xffff0000, v105
    v_lshlrev_b32 v92, 16, v106
    v_and_b32 v93, 0xffff0000, v106
    v_lshlrev_b32 v94, 16, v107
    v_and_b32 v95, 0xffff0000, v107
    s_lshl_b32 s66, s65, 1
    s_lshl_b32 s67, s62, 7
    s_add_u32 s70, s66, s67
    s_waitcnt lgkmcnt(0)
    v_pk_mul_f32 v[80:81], v[80:81], v[88:89]
    v_pk_mul_f32 v[82:83], v[82:83], v[90:91]
    v_pk_mul_f32 v[84:85], v[84:85], v[92:93]
    v_pk_mul_f32 v[86:87], v[86:87], v[94:95]
    v_cvt_pk_bf16_f32 v64, v80, v81
    v_cvt_pk_bf16_f32 v65, v82, v83
    v_cvt_pk_bf16_f32 v66, v84, v85
    v_cvt_pk_bf16_f32 v67, v86, v87
    ds_read_b64_tr_b16 v[112:113], v4 offset:0
    ds_read_b64_tr_b16 v[114:115], v4 offset:128
    ds_read_b64_tr_b16 v[116:117], v6 offset:0
    ds_read_b64_tr_b16 v[118:119], v6 offset:128
    ds_read_b64_tr_b16 v[120:121], v4 offset:64
    ds_read_b64_tr_b16 v[122:123], v4 offset:192
    ds_read_b64_tr_b16 v[124:125], v6 offset:64
    ds_read_b64_tr_b16 v[126:127], v6 offset:192
    ds_read_b64_tr_b16 v[128:129], v6 offset:896
    ds_read_b64_tr_b16 v[130:131], v4 offset:1024
    ds_read_b64_tr_b16 v[132:133], v4 offset:896
    ds_read_b64_tr_b16 v[134:135], v6 offset:1024
    ds_read_b64_tr_b16 v[136:137], v6 offset:960
    ds_read_b64_tr_b16 v[138:139], v4 offset:1088
    ds_read_b64_tr_b16 v[140:141], v4 offset:960
    ds_read_b64_tr_b16 v[142:143], v6 offset:1088
    ds_read_b64_tr_b16 v[144:145], v6 offset:1792
    ds_read_b64_tr_b16 v[146:147], v6 offset:1920
    ds_read_b64_tr_b16 v[148:149], v4 offset:1792
    ds_read_b64_tr_b16 v[150:151], v4 offset:1920
    ds_read_b64_tr_b16 v[152:153], v6 offset:1856
    ds_read_b64_tr_b16 v[154:155], v6 offset:1984
    ds_read_b64_tr_b16 v[156:157], v4 offset:1856
    ds_read_b64_tr_b16 v[158:159], v4 offset:1984
    ds_read_b64_tr_b16 v[160:161], v4 offset:2688
    ds_read_b64_tr_b16 v[162:163], v6 offset:2816
    ds_read_b64_tr_b16 v[164:165], v6 offset:2688
    ds_read_b64_tr_b16 v[166:167], v4 offset:2816
    ds_read_b64_tr_b16 v[168:169], v4 offset:2752
    ds_read_b64_tr_b16 v[170:171], v6 offset:2880
    ds_read_b64_tr_b16 v[172:173], v6 offset:2752
    ds_read_b64_tr_b16 v[174:175], v4 offset:2880
    s_mov_b32 s66, 0
    buffer_load_dwordx4 v[16:19], v2, s[44:47], s66 offen sc1
    s_mov_b32 s66, 4096
    buffer_load_dwordx4 v[20:23], v2, s[44:47], s66 offen sc1
    s_mov_b32 s66, 8192
    buffer_load_dwordx4 v[24:27], v2, s[44:47], s66 offen sc1
    s_mov_b32 s66, 12288
    buffer_load_dwordx4 v[28:31], v2, s[44:47], s66 offen sc1
    s_mov_b32 s66, 16384
    buffer_load_dwordx4 v[32:35], v2, s[44:47], s66 offen sc1
    s_mov_b32 s66, 20480
    buffer_load_dwordx4 v[36:39], v2, s[44:47], s66 offen sc1
    s_mov_b32 s66, 24576
    buffer_load_dwordx4 v[40:43], v2, s[44:47], s66 offen sc1
    s_mov_b32 s66, 28672
    buffer_load_dwordx4 v[44:47], v2, s[44:47], s66 offen sc1
    buffer_store_dwordx4 v[64:67], v110, s[40:43], 0 offen nt
    ds_read_b64_tr_b16 v[176:177], v4 offset:3584
    ds_read_b64_tr_b16 v[178:179], v4 offset:3712
    ds_read_b64_tr_b16 v[180:181], v6 offset:3584
    ds_read_b64_tr_b16 v[182:183], v6 offset:3712
    ds_read_b64_tr_b16 v[184:185], v4 offset:3648
    ds_read_b64_tr_b16 v[186:187], v4 offset:3776
    ds_read_b64_tr_b16 v[188:189], v6 offset:3648
    ds_read_b64_tr_b16 v[190:191], v6 offset:3776
    ds_read_b64_tr_b16 v[192:193], v6 offset:4480
    ds_read_b64_tr_b16 v[194:195], v4 offset:4608
    ds_read_b64_tr_b16 v[196:197], v4 offset:4480
    ds_read_b64_tr_b16 v[198:199], v6 offset:4608
    ds_read_b64_tr_b16 v[200:201], v6 offset:4544
    ds_read_b64_tr_b16 v[202:203], v4 offset:4672
    ds_read_b64_tr_b16 v[204:205], v4 offset:4544
    ds_read_b64_tr_b16 v[206:207], v6 offset:4672
    ds_read_b64_tr_b16 v[208:209], v6 offset:5376
    ds_read_b64_tr_b16 v[210:211], v6 offset:5504
    ds_read_b64_tr_b16 v[212:213], v4 offset:5376
    ds_read_b64_tr_b16 v[214:215], v4 offset:5504
    ds_read_b64_tr_b16 v[216:217], v6 offset:5440
    ds_read_b64_tr_b16 v[218:219], v6 offset:5568
    ds_read_b64_tr_b16 v[220:221], v4 offset:5440
    ds_read_b64_tr_b16 v[222:223], v4 offset:5568
    ds_read_b64_tr_b16 v[224:225], v4 offset:6272
    ds_read_b64_tr_b16 v[226:227], v6 offset:6400
    ds_read_b64_tr_b16 v[228:229], v6 offset:6272
    ds_read_b64_tr_b16 v[230:231], v4 offset:6400
    ds_read_b64_tr_b16 v[232:233], v4 offset:6336
    ds_read_b64_tr_b16 v[234:235], v6 offset:6464
    ds_read_b64_tr_b16 v[236:237], v6 offset:6336
    ds_read_b64_tr_b16 v[238:239], v4 offset:6464
    s_mul_i32 s66, s95, 4352
    s_mul_i32 s67, s101, 57344
    s_add_u32 s66, s66, s67
    v_and_b32 v70, 15, v1
    v_mul_u32_u24 v70, 272, v70
    v_lshrrev_b32 v71, 4, v1
    v_lshl_add_u32 v70, v71, 4, v70
    v_add_u32 v68, s66, v70
    s_mul_i32 s66, s95, 4352
    s_lshl_b32 s67, s101, 7
    s_add_u32 s66, s66, s67
    v_lshrrev_b32 v70, 2, v1
    v_mul_u32_u24 v70, 272, v70
    v_and_b32 v71, 3, v1
    v_lshl_add_u32 v70, v71, 5, v70
    v_add_u32 v69, s66, v70
    s_lshl_b32 s66, s95, 4
    v_lshrrev_b32 v72, 2, v1
    v_add_u32 v72, s66, v72
    v_mul_u32_u24 v72, 1792, v72
    v_and_b32 v73, 3, v1
    v_lshl_add_u32 v72, v73, 4, v72
    s_lshl_b32 s67, s101, 6
    s_add_u32 s70, s70, s67
    s_add_u32 s70, s70, 896
    s_mov_b32 s71, 0
    s_waitcnt lgkmcnt(0)
    s_waitcnt vmcnt(8)
L_oc0:
    v_max3_u32 v3, v16, v17, v18
    v_max_u32 v3, v3, v19
    v_cmp_eq_u32 vcc, -1, v3
    s_nop 0
    s_cbranch_vccnz L_or0_rt
L_og0:
    v_mfma_f32_16x16x32_bf16 v[48:51], v[112:115], v[16:19], 0
    v_mfma_f32_16x16x32_bf16 v[52:55], v[116:119], v[16:19], 0
    v_mfma_f32_16x16x32_bf16 v[56:59], v[120:123], v[16:19], 0
    v_mfma_f32_16x16x32_bf16 v[60:63], v[124:127], v[16:19], 0
    s_waitcnt vmcnt(7)
L_oc1:
    v_max3_u32 v3, v20, v21, v22
    v_max_u32 v3, v3, v23
    v_cmp_eq_u32 vcc, -1, v3
    s_nop 0
    s_cbranch_vccnz L_or1_rt
L_og1:
    v_mfma_f32_16x16x32_bf16 v[48:51], v[128:131], v[20:23], v[48:51]
    v_mfma_f32_16x16x32_bf16 v[52:55], v[132:135], v[20:23], v[52:55]
    v_mfma_f32_16x16x32_bf16 v[56:59], v[136:139], v[20:23], v[56:59]
    v_mfma_f32_16x16x32_bf16 v[60:63], v[140:143], v[20:23], v[60:63]
    s_waitcnt vmcnt(6)
L_oc2:
    v_max3_u32 v3, v24, v25, v26
    v_max_u32 v3, v3, v27
    v_cmp_eq_u32 vcc, -1, v3
    s_nop 0
    s_cbranch_vccnz L_or2_rt
L_og2:
    v_mfma_f32_16x16x32_bf16 v[48:51], v[144:147], v[24:27], v[48:51]
    v_mfma_f32_16x16x32_bf16 v[52:55], v[148:151], v[24:27], v[52:55]
    v_mfma_f32_16x16x32_bf16 v[56:59], v[152:155], v[24:27], v[56:59]
    v_mfma_f32_16x16x32_bf16 v[60:63], v[156:159], v[24:27], v[60:63]
    s_waitcnt vmcnt(5)
L_oc3:
    v_max3_u32 v3, v28, v29, v30
    v_max_u32 v3, v3, v31
    v_cmp_eq_u32 vcc, -1, v3
    s_nop 0
    s_cbranch_vccnz L_or3_rt
L_og3:
    v_mfma_f32_16x16x32_bf16 v[48:51], v[160:163], v[28:31], v[48:51]
    v_mfma_f32_16x16x32_bf16 v[52:55], v[164:167], v[28:31], v[52:55]
    v_mfma_f32_16x16x32_bf16 v[56:59], v[168:171], v[28:31], v[56:59]
    v_mfma_f32_16x16x32_bf16 v[60:63], v[172:175], v[28:31], v[60:63]
    s_waitcnt vmcnt(4)
L_oc4:
    v_max3_u32 v3, v32, v33, v34
    v_max_u32 v3, v3, v35
    v_cmp_eq_u32 vcc, -1, v3
    s_nop 0
    s_cbranch_vccnz L_or4_rt
L_og4:
    v_mfma_f32_16x16x32_bf16 v[48:51], v[176:179], v[32:35], v[48:51]
    v_mfma_f32_16x16x32_bf16 v[52:55], v[180:183], v[32:35], v[52:55]
    v_mfma_f32_16x16x32_bf16 v[56:59], v[184:187], v[32:35], v[56:59]
    v_mfma_f32_16x16x32_bf16 v[60:63], v[188:191], v[32:35], v[60:63]
    s_waitcnt vmcnt(3)
L_oc5:
    v_max3_u32 v3, v36, v37, v38
    v_max_u32 v3, v3, v39
    v_cmp_eq_u32 vcc, -1, v3
    s_nop 0
    s_cbranch_vccnz L_or5_rt
L_og5:
    v_mfma_f32_16x16x32_bf16 v[48:51], v[192:195], v[36:39], v[48:51]
    v_mfma_f32_16x16x32_bf16 v[52:55], v[196:199], v[36:39], v[52:55]
    v_mfma_f32_16x16x32_bf16 v[56:59], v[200:203], v[36:39], v[56:59]
    v_mfma_f32_16x16x32_bf16 v[60:63], v[204:207], v[36:39], v[60:63]
    s_waitcnt vmcnt(2)
L_oc6:
    v_max3_u32 v3, v40, v41, v42
    v_max_u32 v3, v3, v43
    v_cmp_eq_u32 vcc, -1, v3
    s_nop 0
    s_cbranch_vccnz L_or6_rt
L_og6:
    v_mfma_f32_16x16x32_bf16 v[48:51], v[208:211], v[40:43], v[48:51]
    v_mfma_f32_16x16x32_bf16 v[52:55], v[212:215], v[40:43], v[52:55]
    v_mfma_f32_16x16x32_bf16 v[56:59], v[216:219], v[40:43], v[56:59]
    v_mfma_f32_16x16x32_bf16 v[60:63], v[220:223], v[40:43], v[60:63]
    s_waitcnt vmcnt(1)
L_oc7:
    v_max3_u32 v3, v44, v45, v46
    v_max_u32 v3, v3, v47
    v_cmp_eq_u32 vcc, -1, v3
    s_nop 0
    s_cbranch_vccnz L_or7_rt
L_og7:
    v_mfma_f32_16x16x32_bf16 v[48:51], v[224:227], v[44:47], v[48:51]
    v_mfma_f32_16x16x32_bf16 v[52:55], v[228:231], v[44:47], v[52:55]
    v_mfma_f32_16x16x32_bf16 v[56:59], v[232:235], v[44:47], v[56:59]
    v_mfma_f32_16x16x32_bf16 v[60:63], v[236:239], v[44:47], v[60:63]
    s_nop 4
    ds_write_b128 v68, v[48:51] offset:0
    ds_write_b128 v68, v[52:55] offset:64
    ds_write_b128 v68, v[56:59] offset:128
    ds_write_b128 v68, v[60:63] offset:192
    s_waitcnt lgkmcnt(0)
    s_barrier
    ds_read_b128 v[16:19], v69
    ds_read_b128 v[24:27], v69 offset:57344
    ds_read_b128 v[20:23], v69 offset:16
    ds_read_b128 v[32:35], v69 offset:57360
    s_waitcnt lgkmcnt(2)
    v_pk_add_f32 v[16:17], v[16:17], v[24:25]
    v_pk_add_f32 v[18:19], v[18:19], v[26:27]
    v_cvt_pk_bf16_f32 v28, v16, v17
    v_cvt_pk_bf16_f32 v29, v18, v19
    s_waitcnt lgkmcnt(0)
    v_pk_add_f32 v[20:21], v[20:21], v[32:33]
    v_pk_add_f32 v[22:23], v[22:23], v[34:35]
    v_cvt_pk_bf16_f32 v30, v20, v21
    v_cvt_pk_bf16_f32 v31, v22, v23
    buffer_store_dwordx4 v[28:31], v72, s[40:43], s70 offen nt
    s_or_b32 s66, s2, s60
    s_cmp_eq_u32 s66, 0
    s_cbranch_scc0 L_fin
    v_mov_b32 v2, 0
    v_mov_b32 v3, s63
    s_mov_b64 exec, 1
    buffer_store_dword v3, v2, s[44:47], 0 offen sc1
    s_mov_b64 exec, -1
L_fin:
    s_endpgm
L_or0_rt:
    s_add_u32 s71, s71, 1
    s_cmp_gt_u32 s71, 262144
    s_cbranch_scc1 L_og0
    s_waitcnt vmcnt(0)
    s_mov_b32 s66, 0
    buffer_load_dwordx4 v[16:19], v2, s[44:47], s66 offen sc1
    s_mov_b32 s66, 4096
    buffer_load_dwordx4 v[20:23], v2, s[44:47], s66 offen sc1
    s_mov_b32 s66, 8192
    buffer_load_dwordx4 v[24:27], v2, s[44:47], s66 offen sc1
    s_mov_b32 s66, 12288
    buffer_load_dwordx4 v[28:31], v2, s[44:47], s66 offen sc1
    s_mov_b32 s66, 16384
    buffer_load_dwordx4 v[32:35], v2, s[44:47], s66 offen sc1
    s_mov_b32 s66, 20480
    buffer_load_dwordx4 v[36:39], v2, s[44:47], s66 offen sc1
    s_mov_b32 s66, 24576
    buffer_load_dwordx4 v[40:43], v2, s[44:47], s66 offen sc1
    s_mov_b32 s66, 28672
    buffer_load_dwordx4 v[44:47], v2, s[44:47], s66 offen sc1
    s_waitcnt vmcnt(0)
    s_branch L_oc0
L_or1_rt:
    s_add_u32 s71, s71, 1
    s_cmp_gt_u32 s71, 262144
    s_cbranch_scc1 L_og1
    s_waitcnt vmcnt(0)
    s_mov_b32 s66, 4096
    buffer_load_dwordx4 v[20:23], v2, s[44:47], s66 offen sc1
    s_mov_b32 s66, 8192
    buffer_load_dwordx4 v[24:27], v2, s[44:47], s66 offen sc1
    s_mov_b32 s66, 12288
    buffer_load_dwordx4 v[28:31], v2, s[44:47], s66 offen sc1
    s_mov_b32 s66, 16384
    buffer_load_dwordx4 v[32:35], v2, s[44:47], s66 offen sc1
    s_mov_b32 s66, 20480
    buffer_load_dwordx4 v[36:39], v2, s[44:47], s66 offen sc1
    s_mov_b32 s66, 24576
    buffer_load_dwordx4 v[40:43], v2, s[44:47], s66 offen sc1
    s_mov_b32 s66, 28672
    buffer_load_dwordx4 v[44:47], v2, s[44:47], s66 offen sc1
    s_waitcnt vmcnt(0)
    s_branch L_oc1
L_or2_rt:
    s_add_u32 s71, s71, 1
    s_cmp_gt_u32 s71, 262144
    s_cbranch_scc1 L_og2
    s_waitcnt vmcnt(0)
    s_mov_b32 s66, 8192
    buffer_load_dwordx4 v[24:27], v2, s[44:47], s66 offen sc1
    s_mov_b32 s66, 12288
    buffer_load_dwordx4 v[28:31], v2, s[44:47], s66 offen sc1
    s_mov_b32 s66, 16384
    buffer_load_dwordx4 v[32:35], v2, s[44:47], s66 offen sc1
    s_mov_b32 s66, 20480
    buffer_load_dwordx4 v[36:39], v2, s[44:47], s66 offen sc1
    s_mov_b32 s66, 24576
    buffer_load_dwordx4 v[40:43], v2, s[44:47], s66 offen sc1
    s_mov_b32 s66, 28672
    buffer_load_dwordx4 v[44:47], v2, s[44:47], s66 offen sc1
    s_waitcnt vmcnt(0)
    s_branch L_oc2
L_or3_rt:
    s_add_u32 s71, s71, 1
    s_cmp_gt_u32 s71, 262144
    s_cbranch_scc1 L_og3
    s_waitcnt vmcnt(0)
    s_mov_b32 s66, 12288
    buffer_load_dwordx4 v[28:31], v2, s[44:47], s66 offen sc1
    s_mov_b32 s66, 16384
    buffer_load_dwordx4 v[32:35], v2, s[44:47], s66 offen sc1
    s_mov_b32 s66, 20480
    buffer_load_dwordx4 v[36:39], v2, s[44:47], s66 offen sc1
    s_mov_b32 s66, 24576
    buffer_load_dwordx4 v[40:43], v2, s[44:47], s66 offen sc1
    s_mov_b32 s66, 28672
    buffer_load_dwordx4 v[44:47], v2, s[44:47], s66 offen sc1
    s_waitcnt vmcnt(0)
    s_branch L_oc3
L_or4_rt:
    s_add_u32 s71, s71, 1
    s_cmp_gt_u32 s71, 262144
    s_cbranch_scc1 L_og4
    s_waitcnt vmcnt(0)
    s_mov_b32 s66, 16384
    buffer_load_dwordx4 v[32:35], v2, s[44:47], s66 offen sc1
    s_mov_b32 s66, 20480
    buffer_load_dwordx4 v[36:39], v2, s[44:47], s66 offen sc1
    s_mov_b32 s66, 24576
    buffer_load_dwordx4 v[40:43], v2, s[44:47], s66 offen sc1
    s_mov_b32 s66, 28672
    buffer_load_dwordx4 v[44:47], v2, s[44:47], s66 offen sc1
    s_waitcnt vmcnt(0)
    s_branch L_oc4
L_or5_rt:
    s_add_u32 s71, s71, 1
    s_cmp_gt_u32 s71, 262144
    s_cbranch_scc1 L_og5
    s_waitcnt vmcnt(0)
    s_mov_b32 s66, 20480
    buffer_load_dwordx4 v[36:39], v2, s[44:47], s66 offen sc1
    s_mov_b32 s66, 24576
    buffer_load_dwordx4 v[40:43], v2, s[44:47], s66 offen sc1
    s_mov_b32 s66, 28672
    buffer_load_dwordx4 v[44:47], v2, s[44:47], s66 offen sc1
    s_waitcnt vmcnt(0)
    s_branch L_oc5
L_or6_rt:
    s_add_u32 s71, s71, 1
    s_cmp_gt_u32 s71, 262144
    s_cbranch_scc1 L_og6
    s_waitcnt vmcnt(0)
    s_mov_b32 s66, 24576
    buffer_load_dwordx4 v[40:43], v2, s[44:47], s66 offen sc1
    s_mov_b32 s66, 28672
    buffer_load_dwordx4 v[44:47], v2, s[44:47], s66 offen sc1
    s_waitcnt vmcnt(0)
    s_branch L_oc6
L_or7_rt:
    s_add_u32 s71, s71, 1
    s_cmp_gt_u32 s71, 262144
    s_cbranch_scc1 L_og7
    s_waitcnt vmcnt(0)
    s_mov_b32 s66, 28672
    buffer_load_dwordx4 v[44:47], v2, s[44:47], s66 offen sc1
    s_waitcnt vmcnt(0)
    s_branch L_oc7
L_end:
    s_endpgm
.section .rodata,"a"
.p2align 6
.amdhsa_kernel concat_heads__ssm_conv_h3__grouped_kv_mqa__prompt_kernel
  .amdhsa_next_free_vgpr 256
  .amdhsa_next_free_sgpr 102
  .amdhsa_accum_offset 256
  .amdhsa_group_segment_fixed_size 0
  .amdhsa_kernarg_size 112
  .amdhsa_user_sgpr_count 2
  .amdhsa_user_sgpr_kernarg_segment_ptr 1
  .amdhsa_system_sgpr_workgroup_id_x 1
  .amdhsa_float_denorm_mode_32 3
.end_amdhsa_kernel
```
